```python
import torch

def _softmax(x, axis=-1):
    return torch.softmax(x, dim=axis)

def _gelu(x):
    return torch.nn.functional.gelu(x, approximate='tanh')

def _silu(x):
    return torch.nn.functional.silu(x)

def _sigmoid(x):
    return torch.sigmoid(x)

def _layernorm(x, axis=-1, eps=1e-05):
    m = x.mean(dim=axis, keepdim=True)
    v = x.var(dim=axis, keepdim=True, unbiased=False)
    return (x - m) / torch.sqrt(v + eps)

def _scatter_add(tgt, idx, src, axis=0):
    return tgt.clone().index_add_(axis, idx, src)

def _segment_sum(src, seg, n):
    out = torch.zeros((n,) + src.shape[1:], dtype=src.dtype)
    return out.index_add_(0, seg, src)

def _pad(x, pw):
    flat = tuple((v for pair in reversed(pw) for v in pair))
    return torch.nn.functional.pad(x, flat)
kernel_name = 'standalone__autoregressive_conv_wavenet__speech'

def setup_inputs():

    _w = lambda a: (lambda t: t.to(torch.bfloat16) if t.is_floating_point() else t)(torch.as_tensor(a))
    B, T, D, K = (2, 4000, 144, 31)
    return {'x': _w((lambda *s: torch.randn(*s, dtype=torch.bfloat16) * 0.1)(B, T, D)), 'w': _w((lambda *s: torch.randn(*s, dtype=torch.bfloat16) * 0.1)(K, D, 2 * D)), 'w_o': _w((lambda *s: torch.randn(*s, dtype=torch.bfloat16) * 0.05)(D, D))}

def reference(x, w, w_o):
    B, T, D = x.shape
    K = w.shape[0]
    dil = 2
    pad = (K - 1) * dil
    xp = _pad(x, ((0, 0), (pad, 0), (0, 0)))
    h = torch.einsum('btc,cd->btd', xp[:, pad:pad + T, :], w[0])
    for i in range(1, K):
        off = pad - i * dil
        h = h + torch.einsum('btc,cd->btd', xp[:, off:off + T, :], w[i])
    f = h[..., :D].clone()
    g = h[..., D:].clone()
    z = torch.tanh(f) * _sigmoid(g)
    return z @ w_o
```

```asm
; @launch grid=(256,1,1) block=(256,1,1) lds=161952
.amdgcn_target "amdgcn-amd-amdhsa--gfx950"
.text
.globl standalone__autoregressive_conv_wavenet__speech_kernel
.p2align 8
.type standalone__autoregressive_conv_wavenet__speech_kernel,@function
standalone__autoregressive_conv_wavenet__speech_kernel:
    s_load_dwordx4 s[4:7], s[0:1], 0
    s_load_dwordx4 s[8:11], s[0:1], 16
    s_load_dwordx4 s[12:15], s[0:1], 32
    s_getpc_b64 s[20:21]
L_pc0:
    s_lshr_b32 s22, s2, 3
    s_mul_i32 s22, s22, 9
    v_lshrrev_b32 v4, 4, v0
    v_and_b32 v4, 12, v4
    v_and_b32 v5, 3, v0
    v_add3_u32 v4, v4, v5, s22
    s_mov_b32 s22, (L_code_end-L_pc0-4)/128
    v_min_u32 v4, s22, v4
    v_lshlrev_b32 v4, 7, v4
    v_mov_b32 v7, s21
    v_add_co_u32 v6, vcc, s20, v4
    s_nop 1
    v_addc_co_u32 v7, vcc, 0, v7, vcc
    global_load_dword v70, v[6:7], off
    s_cmp_ge_u32 s2, 256
    s_cbranch_scc1 L_end
    s_and_b32 s50, s2, 7
    s_lshr_b32 s51, s2, 3
    s_mul_i32 s52, s51, 57
    s_lshr_b32 s52, s52, 9
    s_mul_i32 s36, s50, 3
    s_add_u32 s36, s36, s52
    s_mul_i32 s37, s52, 9
    s_sub_u32 s37, s51, s37
    s_cmp_lt_u32 s51, 27
    s_cbranch_scc1 L_ids
    s_lshr_b32 s36, s50, 1
    s_add_u32 s36, s36, 24
    s_and_b32 s50, s50, 1
    s_mul_i32 s50, s50, 5
    s_add_u32 s37, s37, s50
    s_cmp_ge_u32 s37, 9
    s_cbranch_scc1 L_end
L_ids:
    s_mul_i32 s48, s36, 9
    s_add_u32 s48, s48, s37
    s_and_b32 s40, s36, 1
    s_lshr_b32 s38, s36, 1
    s_cmp_ge_u32 s38, 7
    s_cselect_b32 s41, 1, 0
    s_mul_i32 s50, s41, 7
    s_sub_u32 s38, s38, s50
    s_mul_i32 s45, s38, 143
    s_sub_u32 s45, s45, 1
    v_lshrrev_b32 v4, 6, v0
    v_and_b32 v1, 63, v0
    v_readfirstlane_b32 s42, v4
    v_and_b32 v2, 15, v1
    v_lshrrev_b32 v3, 4, v1
    s_and_b32 s43, s42, 1
    s_lshr_b32 s44, s42, 1
    s_mul_i32 s50, s41, 1152000
    s_sub_u32 s51, s45, 15
    s_mul_i32 s51, s51, 1152
    s_mul_i32 s52, s40, 288
    s_add_u32 s51, s51, s52
    s_mul_i32 s53, s42, 9
    v_lshrrev_b32 v8, 2, v1
    v_min_u32 v8, 8, v8
    v_add_u32 v8, s53, v8
    v_lshrrev_b32 v9, 1, v8
    s_mul_i32 s52, s37, 18
    v_add_u32 v9, s52, v9
    v_mul_u32_u24 v9, 1152, v9
    v_and_b32 v8, 1, v8
    v_mul_u32_u24 v8, 576, v8
    v_and_b32 v7, 3, v1
    v_mul_u32_u24 v7, 92, v7
    v_add3_u32 v9, v9, v8, v7
    v_add_u32 v22, s51, v9
    v_and_b32 v22, -4, v22
    s_waitcnt lgkmcnt(0)
    s_add_u32 s16, s4, s50
    s_addc_u32 s17, s5, 0
    s_and_b32 s17, s17, 0xffff
    s_mov_b32 s18, 1152000
    s_mov_b32 s19, 0x20000
    buffer_load_dword v68, v22, s[16:19], 0 offen
    s_mov_b32 s20, s6
    s_and_b32 s21, s7, 0xffff
    s_mov_b32 s22, 2571264
    s_mov_b32 s23, 0x20000
    s_lshl_b32 s52, s48, 2
    s_add_u32 s52, s52, s42
    s_mul_i32 s52, s52, 3
    v_min_u32 v4, 2, v1
    v_add_u32 v9, s52, v4
    v_mul_u32_u24 v5, 3641, v9
    v_lshrrev_b32 v5, 20, v5
    v_mul_u32_u24 v6, 288, v5
    v_sub_u32 v6, v9, v6
    v_mul_u32_u24 v23, 82944, v5
    v_cmp_le_u32 vcc, 144, v6
    v_lshlrev_b32 v7, 7, v6
    v_add_u32 v23, v23, v7
    v_add_u32 v7, 18432, v23
    v_cndmask_b32 v23, v23, v7, vcc
    v_cmp_le_u32 vcc, 8, v5
    v_mov_b32 v7, 0x7fffffff
    s_mov_b32 s100, 663552
    v_cndmask_b32 v0, v23, v7, vcc
    buffer_load_dword v69, v0, s[20:23], 0 offen
    buffer_load_dword v69, v0, s[20:23], s100 offen
    v_mul_u32_u24 v4, 3641, v1
    v_lshrrev_b32 v4, 16, v4
    v_mul_u32_u24 v6, 18, v4
    v_sub_u32 v6, v1, v6
    v_mul_u32_u24 v4, 1152, v4
    v_lshlrev_b32 v6, 4, v6
    v_add3_u32 v4, v4, v6, s51
    s_mul_i32 s51, s42, 3456
    v_add_u32 v21, s51, v4
    v_add_u32 v146, 576, v21
    v_add_u32 v145, 179712, v4
    v_add_u32 v144, 180288, v4
    s_mul_i32 s3, s42, 864
    v_lshrrev_b32 v4, 3, v1
    v_lshrrev_b32 v5, 2, v4
    v_lshlrev_b32 v5, 4, v5
    v_and_b32 v6, 1, v4
    v_lshlrev_b32 v6, 3, v6
    v_add_u32 v5, v5, v6
    v_and_b32 v6, 2, v4
    v_lshlrev_b32 v6, 1, v6
    v_add_u32 v5, v5, v6
    v_bfe_u32 v6, v1, 1, 2
    v_add_u32 v5, v5, v6
    v_and_b32 v6, 1, v1
    v_lshlrev_b32 v6, 4, v6
    s_lshl_b32 s52, s37, 6
    s_lshl_b32 s51, s43, 5
    s_add_u32 s52, s52, s51
    v_mul_u32_u24 v7, 576, v5
    v_add3_u32 v7, v7, v6, s52
    s_mul_i32 s51, s44, 36864
    v_add_u32 v16, s51, v7
    s_mul_i32 s46, s42, 6144
    s_add_u32 s46, s46, 137376
    s_add_u32 s57, s46, 0
    s_add_u32 s58, s46, 1024
    s_add_u32 s59, s46, 2048
    s_add_u32 s60, s46, 3072
    s_add_u32 s61, s46, 4096
    s_add_u32 s62, s46, 5120
    s_mov_b32 s55, 82944
    s_mov_b32 s56, 248832
    s_mov_b32 s47, 0xffff0000
    s_mov_b32 m0, s57
    s_mov_b32 s54, 0
    buffer_load_dwordx4 v16, s[20:23], s54 offen lds
    s_mov_b32 m0, s58
    s_add_u32 s54, s54, s55
    buffer_load_dwordx4 v16, s[20:23], s54 offen lds
    v_mul_u32_u24 v4, 2592, v2
    v_lshlrev_b32 v5, 4, v3
    s_lshl_b32 s52, s44, 7
    v_add3_u32 v10, v4, v5, s52
    v_add_u32 v11, 45792, v10
    v_add_u32 v12, 91584, v10
    v_lshrrev_b32 v4, 1, v3
    v_lshlrev_b32 v4, 9, v4
    v_and_b32 v5, 1, v3
    v_lshlrev_b32 v5, 7, v5
    v_add_u32 v4, v4, v5
    v_lshrrev_b32 v5, 2, v2
    v_lshlrev_b32 v5, 5, v5
    v_add_u32 v4, v4, v5
    v_and_b32 v5, 3, v2
    v_lshlrev_b32 v5, 3, v5
    v_add_u32 v4, v4, v5
    v_add_u32 v18, s46, v4
    v_mul_u32_u24 v4, 288, v2
    v_lshrrev_b32 v5, 1, v3
    v_mul_u32_u24 v6, 45792, v5
    v_and_b32 v7, 1, v3
    s_lshl_b32 s51, s43, 5
    s_add_u32 s52, s52, s51
    v_add3_u32 v6, v4, v6, s52
    v_lshlrev_b32 v8, 4, v7
    v_add_u32 v19, v6, v8
    v_lshlrev_b32 v5, 4, v5
    s_add_u32 s52, s52, 91584
    v_add3_u32 v4, v4, v5, s52
    v_mul_u32_u24 v6, 4608, v7
    v_add_u32 v86, v4, v6
    v_mul_u32_u24 v6, 4320, v7
    v_add_u32 v87, v4, v6
    v_lshrrev_b32 v4, 3, v2
    v_cmp_eq_u32 vcc, v4, v7
    v_and_b32 v4, 1, v2
    v_lshlrev_b32 v4, 4, v4
    v_mov_b32 v5, 0x3f80
    v_lshlrev_b32 v4, v4, v5
    v_cndmask_b32 v4, 0, v4, vcc
    v_bfe_u32 v5, v2, 1, 2
    v_cmp_eq_u32 s[4:5], 0, v5
    v_cmp_eq_u32 s[6:7], 1, v5
    s_nop 0
    v_cndmask_b32 v24, 0, v4, s[4:5]
    v_cndmask_b32 v25, 0, v4, s[6:7]
    v_cmp_eq_u32 s[4:5], 2, v5
    v_cmp_eq_u32 s[6:7], 3, v5
    s_nop 0
    v_cndmask_b32 v26, 0, v4, s[4:5]
    v_cndmask_b32 v27, 0, v4, s[6:7]
    s_mov_b32 exec_hi, 0x3fffff
    s_mov_b32 s5, 13
L_xst:
    s_mov_b32 m0, s3
    s_add_u32 s4, s3, 45792
    buffer_load_dwordx4 v21, s[16:19], 0 offen lds
    s_mov_b32 m0, s4
    s_add_u32 s3, s3, 3456
    buffer_load_dwordx4 v146, s[16:19], 0 offen lds
    v_add_u32 v21, 13824, v21
    v_add_u32 v146, 13824, v146
    s_sub_u32 s5, s5, 1
    s_cmp_lg_u32 s5, 0
    s_cbranch_scc1 L_xst
    s_cmp_lt_u32 s42, 2
    s_cbranch_scc0 L_xlast
    s_mul_i32 s4, s42, 45792
    s_add_u32 m0, s4, 44928
    s_mul_i32 s4, s42, 576
    v_add_u32 v145, s4, v145
    buffer_load_dwordx4 v145, s[16:19], 0 offen lds
L_xlast:
    s_mov_b32 exec_hi, -1
    s_mov_b32 m0, s59
    s_add_u32 s54, s54, s55
    buffer_load_dwordx4 v16, s[20:23], s54 offen lds
    s_mov_b32 m0, s60
    s_add_u32 s54, s54, s55
    buffer_load_dwordx4 v16, s[20:23], s54 offen lds
    s_mov_b32 m0, s61
    s_add_u32 s54, s54, s55
    buffer_load_dwordx4 v16, s[20:23], s54 offen lds
    s_mov_b32 m0, s62
    s_add_u32 s54, s54, s55
    buffer_load_dwordx4 v16, s[20:23], s54 offen lds
    s_mov_b32 s32, s14
    s_and_b32 s33, s15, 0xffff
    s_mov_b32 s34, 268435456
    s_mov_b32 s35, 0x20000
    s_lshl_b32 s52, s36, 8
    s_add_u32 s52, s52, 128
    v_mov_b32 v9, s52
    buffer_load_dword v9, v9, s[32:35], 0 offen sc1
    v_mul_u32_u24 v4, 288, v2
    v_lshlrev_b32 v6, 3, v3
    s_lshl_b32 s4, s44, 7
    s_lshl_b32 s5, s43, 5
    s_add_u32 s4, s4, s5
    s_add_u32 s4, s4, 91584
    v_add3_u32 v20, v4, v6, s4
    s_mul_i32 s4, s36, 165888
    s_lshl_b32 s5, s37, 11
    s_add_u32 s4, s4, s5
    s_lshl_b32 s5, s44, 10
    s_add_u32 s4, s4, s5
    s_lshl_b32 s5, s43, 9
    s_add_u32 s4, s4, s5
    s_add_u32 s4, s4, 1048576
    v_and_b32 v4, 1, v3
    v_mul_u32_u24 v5, 18432, v4
    v_lshrrev_b32 v6, 1, v3
    v_lshlrev_b32 v6, 8, v6
    v_lshlrev_b32 v7, 4, v2
    v_add3_u32 v5, v5, v6, v7
    v_add_u32 v100, s4, v5
    v_cmp_eq_u32 vcc, 1, v4
    v_mov_b32 v6, 0x7fffffff
    s_nop 0
    v_cndmask_b32 v101, v100, v6, vcc
    s_mov_b32 s24, s8
    s_and_b32 s25, s9, 0xffff
    s_mov_b32 s26, 41472
    s_mov_b32 s27, 0x20000
    s_add_u32 s28, s10, s50
    s_addc_u32 s29, s11, 0
    s_and_b32 s29, s29, 0xffff
    s_mov_b32 s30, 1152000
    s_mov_b32 s31, 0x20000
    s_lshl_b32 s4, s48, 2
    s_add_u32 s4, s4, s42
    s_mul_i32 s5, s4, 203
    s_lshr_b32 s5, s5, 16
    s_mul_i32 s5, s5, 324
    s_sub_u32 s4, s4, s5
    s_lshl_b32 s4, s4, 7
    v_mov_b32 v142, s4
    v_mul_u32_u24 v4, 2592, v2
    v_and_b32 v5, 1, v3
    v_lshlrev_b32 v5, 4, v5
    v_add_u32 v5, v4, v5
    v_lshrrev_b32 v6, 1, v3
    v_mul_u32_u24 v6, 288, v6
    v_sub_u32 v5, v5, v6
    s_mul_i32 s4, s44, 2304
    s_sub_u32 s4, 256, s4
    v_add_u32 v13, s4, v5
    v_add_u32 v14, 45792, v13
    v_add_u32 v15, 91584, v13
    v_mul_u32_u24 v4, 288, v2
    v_lshrrev_b32 v5, 1, v3
    v_mul_u32_u24 v5, 45792, v5
    v_and_b32 v6, 1, v3
    v_lshlrev_b32 v6, 4, v6
    v_add3_u32 v5, v4, v5, v6
    v_lshlrev_b32 v6, 3, v3
    v_add_u32 v6, v4, v6
    v_add_u32 v6, 91584, v6
    s_mul_i32 s4, s42, 4608
    s_add_u32 s4, s4, 256
    v_add_u32 v88, s4, v5
    v_add_u32 v89, s4, v6
    s_lshl_b32 s4, s42, 4
    s_add_u32 s4, s4, 128
    s_min_u32 s4, s4, 143
    s_mul_i32 s4, s4, 288
    s_add_u32 s4, s4, 256
    v_add_u32 v90, s4, v5
    v_add_u32 v91, s4, v6
    v_lshrrev_b32 v4, 3, v1
    v_lshrrev_b32 v5, 2, v4
    v_lshlrev_b32 v5, 4, v5
    v_and_b32 v6, 1, v4
    v_lshlrev_b32 v6, 3, v6
    v_add_u32 v5, v5, v6
    v_and_b32 v6, 2, v4
    v_lshlrev_b32 v6, 1, v6
    v_add_u32 v5, v5, v6
    v_bfe_u32 v6, v1, 1, 2
    v_add_u32 v5, v5, v6
    v_and_b32 v6, 1, v1
    v_lshlrev_b32 v6, 4, v6
    s_lshl_b32 s4, s37, 6
    s_lshl_b32 s5, s43, 5
    s_add_u32 s4, s4, s5
    v_add_u32 v6, s4, v6
    v_and_b32 v7, 15, v5
    v_mul_u32_u24 v7, 576, v7
    v_lshrrev_b32 v5, 4, v5
    v_mul_u32_u24 v5, 165888, v5
    v_add3_u32 v7, v7, v5, v6
    s_mul_i32 s4, s44, 1327104
    s_add_u32 s4, s4, 73728
    v_add_u32 v17, s4, v7
    s_lshl_b32 s4, s48, 2
    s_add_u32 s4, s4, s42
    s_mul_i32 s4, s4, 3
    v_min_u32 v4, 2, v1
    v_add_u32 v4, s4, v4
    v_mul_u32_u24 v5, 14564, v4
    v_lshrrev_b32 v5, 20, v5
    v_mul_u32_u24 v6, 72, v5
    v_sub_u32 v6, v4, v6
    v_lshlrev_b32 v6, 7, v6
    v_mul_u32_u24 v5, 82944, v5
    s_mov_b32 s4, 73728
    v_add3_u32 v102, v5, v6, s4
    s_lshl_b32 s4, s36, 8
    s_lshl_b32 s5, s37, 2
    s_add_u32 s5, s5, s4
    v_mov_b32 v4, s5
    v_or_b32 v5, s42, v1
    v_cmp_eq_u32 vcc, 0, v5
    v_mov_b32 v6, 0x7fffffff
    v_min_u32 v7, 8, v1
    v_cndmask_b32 v22, v6, v4, vcc
    v_lshlrev_b32 v7, 2, v7
    v_add_u32 v23, s4, v7
    s_mov_b32 s100, 0
    buffer_load_dword v21, v142, s[24:27], s100 offen
    s_waitcnt vmcnt(32)
    ds_read_b64_tr_b16 v[28:29], v18 offset:0
    ds_read_b64_tr_b16 v[30:31], v18 offset:256
    ds_read_b64_tr_b16 v[36:37], v18 offset:1024
    ds_read_b64_tr_b16 v[38:39], v18 offset:1280
    s_waitcnt vmcnt(6)
    s_waitcnt lgkmcnt(0)
    s_mov_b32 m0, s57
    s_add_u32 s54, s54, s55
    buffer_load_dwordx4 v16, s[20:23], s54 offen lds
    s_mov_b32 m0, s58
    s_add_u32 s54, s54, s55
    buffer_load_dwordx4 v16, s[20:23], s54 offen lds
    s_barrier
    ds_read_b128 a[0:3], v10 offset:4320
    ds_read_b128 a[4:7], v10 offset:4608
    ds_read_b128 a[8:11], v10 offset:4896
    ds_read_b128 a[12:15], v10 offset:5184
    ds_read_b128 a[16:19], v10 offset:5472
    ds_read_b128 a[20:23], v10 offset:5760
    ds_read_b128 a[24:27], v10 offset:6048
    ds_read_b128 a[28:31], v10 offset:6336
    ds_read_b128 a[32:35], v10 offset:6624
    ds_read_b128 a[84:87], v11 offset:4320
    ds_read_b128 a[88:91], v11 offset:4608
    ds_read_b128 a[92:95], v11 offset:4896
    ds_read_b128 a[96:99], v11 offset:5184
    ds_read_b128 a[100:103], v11 offset:5472
    ds_read_b128 a[104:107], v11 offset:5760
    ds_read_b128 a[108:111], v11 offset:6048
    ds_read_b128 a[112:115], v11 offset:6336
    ds_read_b128 a[116:119], v11 offset:6624
    s_waitcnt lgkmcnt(15)
    v_mfma_f32_16x16x32_bf16 v[148:151], v[28:31], a[0:3], 0
    s_waitcnt vmcnt(6)
    ds_read_b64_tr_b16 v[32:33], v18 offset:2048
    ds_read_b64_tr_b16 v[34:35], v18 offset:2304
    v_mfma_f32_16x16x32_bf16 v[152:155], v[28:31], a[4:7], 0
    ds_read_b64_tr_b16 v[40:41], v18 offset:3072
    ds_read_b64_tr_b16 v[42:43], v18 offset:3328
    v_mfma_f32_16x16x32_bf16 v[156:159], v[28:31], a[8:11], 0
    ds_read_b128 v[104:107], v19 offset:0
    ds_read_b128 v[108:111], v19 offset:4608
    s_waitcnt lgkmcnt(15)
    v_mfma_f32_16x16x32_bf16 v[160:163], v[28:31], a[12:15], 0
    ds_read_b128 v[112:115], v19 offset:9216
    ds_read_b128 v[116:119], v19 offset:13824
    v_mfma_f32_16x16x32_bf16 v[164:167], v[28:31], a[16:19], 0
    ds_read_b128 v[120:123], v19 offset:18432
    ds_read_b128 v[124:127], v19 offset:23040
    v_mfma_f32_16x16x32_bf16 v[168:171], v[28:31], a[20:23], 0
    ds_read_b128 v[128:131], v19 offset:27648
    ds_read_b128 v[132:135], v19 offset:32256
    v_mfma_f32_16x16x32_bf16 v[172:175], v[28:31], a[24:27], 0
    ds_read_b128 v[136:139], v19 offset:36864
    ds_read_b128 v[140:143], v19 offset:41184
    v_mfma_f32_16x16x32_bf16 v[176:179], v[28:31], a[28:31], 0
    ds_read_b128 a[36:39], v10 offset:4032
    ds_read_b128 a[120:123], v11 offset:4032
    s_waitcnt vmcnt(4)
    v_mfma_f32_16x16x32_bf16 v[180:183], v[28:31], a[32:35], 0
    ds_read_b64_tr_b16 v[92:93], v18 offset:4096
    ds_read_b64_tr_b16 v[94:95], v18 offset:4352
    s_waitcnt lgkmcnt(15)
    v_mfma_f32_16x16x32_bf16 v[184:187], v[36:39], a[84:87], 0
    ds_read_b64_tr_b16 v[96:97], v18 offset:5120
    ds_read_b64_tr_b16 v[98:99], v18 offset:5376
    s_waitcnt lgkmcnt(15)
    v_mfma_f32_16x16x32_bf16 v[220:223], v[24:27], v[104:107], 0
    v_mfma_f32_16x16x32_bf16 v[188:191], v[36:39], a[88:91], 0
    s_waitcnt lgkmcnt(14)
    v_mfma_f32_16x16x32_bf16 v[224:227], v[24:27], v[108:111], 0
    v_lshlrev_b32 v52, 16, v28
    v_lshlrev_b32 v56, 16, v29
    v_mfma_f32_16x16x32_bf16 v[192:195], v[36:39], a[92:95], 0
    s_waitcnt lgkmcnt(13)
    v_mfma_f32_16x16x32_bf16 v[228:231], v[24:27], v[112:115], 0
    v_lshlrev_b32 v60, 16, v30
    v_lshlrev_b32 v64, 16, v31
    v_mfma_f32_16x16x32_bf16 v[196:199], v[36:39], a[96:99], 0
    s_waitcnt lgkmcnt(12)
    v_mfma_f32_16x16x32_bf16 v[232:235], v[24:27], v[116:119], 0
    v_lshlrev_b32 v53, 16, v36
    v_lshlrev_b32 v57, 16, v37
    v_mfma_f32_16x16x32_bf16 v[200:203], v[36:39], a[100:103], 0
    s_waitcnt lgkmcnt(11)
    v_mfma_f32_16x16x32_bf16 v[236:239], v[24:27], v[120:123], 0
    v_lshlrev_b32 v61, 16, v38
    v_lshlrev_b32 v65, 16, v39
    v_mfma_f32_16x16x32_bf16 v[204:207], v[36:39], a[104:107], 0
    s_waitcnt lgkmcnt(10)
    v_mfma_f32_16x16x32_bf16 v[240:243], v[24:27], v[124:127], 0
    v_and_b32 v54, s47, v28
    v_and_b32 v58, s47, v29
    v_mfma_f32_16x16x32_bf16 v[208:211], v[36:39], a[108:111], 0
    s_waitcnt lgkmcnt(9)
    v_mfma_f32_16x16x32_bf16 v[244:247], v[24:27], v[128:131], 0
    v_and_b32 v62, s47, v30
    v_and_b32 v66, s47, v31
    v_mfma_f32_16x16x32_bf16 v[212:215], v[36:39], a[112:115], 0
    s_waitcnt lgkmcnt(8)
    v_mfma_f32_16x16x32_bf16 v[248:251], v[24:27], v[132:135], 0
    v_and_b32 v55, s47, v36
    v_and_b32 v59, s47, v37
    v_mfma_f32_16x16x32_bf16 v[216:219], v[36:39], a[116:119], 0
    s_waitcnt lgkmcnt(7)
    v_mfma_f32_16x16x32_bf16 v[252:255], v[24:27], v[136:139], 0
    v_and_b32 v63, s47, v38
    v_and_b32 v67, s47, v39
    s_waitcnt lgkmcnt(6)
    v_mfma_f32_16x16x32_bf16 v[68:71], v[24:27], v[140:143], 0
    v_add_f32 v52, v52, v53
    v_add_f32 v56, v56, v57
    v_add_f32 v60, v60, v61
    v_add_f32 v64, v64, v65
    v_add_f32 v54, v54, v55
    v_add_f32 v58, v58, v59
    v_add_f32 v62, v62, v63
    v_add_f32 v66, v66, v67
    v_cvt_pk_bf16_f32 v44, v52, v54
    v_cvt_pk_bf16_f32 v45, v56, v58
    v_cvt_pk_bf16_f32 v46, v60, v62
    v_cvt_pk_bf16_f32 v47, v64, v66
    s_waitcnt lgkmcnt(5)
    v_mfma_f32_16x16x32_bf16 v[148:151], v[32:35], a[36:39], v[148:151]
    s_mov_b32 m0, s59
    s_add_u32 s54, s54, s55
    buffer_load_dwordx4 v16, s[20:23], s54 offen lds
    v_mfma_f32_16x16x32_bf16 v[152:155], v[32:35], a[0:3], v[152:155]
    s_mov_b32 m0, s60
    s_add_u32 s54, s54, s55
    buffer_load_dwordx4 v16, s[20:23], s54 offen lds
    v_mfma_f32_16x16x32_bf16 v[156:159], v[32:35], a[4:7], v[156:159]
    s_mov_b32 s100, 1327104
    buffer_load_dword v21, v0, s[20:23], s100 offen
    v_mfma_f32_16x16x32_bf16 v[160:163], v[32:35], a[8:11], v[160:163]
    ds_read_b128 a[40:43], v10 offset:3744
    v_cvt_pk_bf16_f32 v220, v220, v221
    v_mfma_f32_16x16x32_bf16 v[164:167], v[32:35], a[12:15], v[164:167]
    ds_read_b128 a[124:127], v11 offset:3744
    v_cvt_pk_bf16_f32 v221, v222, v223
    v_mfma_f32_16x16x32_bf16 v[168:171], v[32:35], a[16:19], v[168:171]
    v_cvt_pk_bf16_f32 v222, v224, v225
    v_cvt_pk_bf16_f32 v223, v226, v227
    v_mfma_f32_16x16x32_bf16 v[172:175], v[32:35], a[20:23], v[172:175]
    s_nop 1
    v_permlane16_swap_b32 v220, v222
    v_mfma_f32_16x16x32_bf16 v[176:179], v[32:35], a[24:27], v[176:179]
    v_permlane16_swap_b32 v221, v223
    ds_write_b128 v86, v[220:223] offset:0
    v_mfma_f32_16x16x32_bf16 v[180:183], v[32:35], a[28:31], v[180:183]
    v_cvt_pk_bf16_f32 v228, v228, v229
    v_cvt_pk_bf16_f32 v229, v230, v231
    s_waitcnt lgkmcnt(7)
    v_mfma_f32_16x16x32_bf16 v[184:187], v[40:43], a[120:123], v[184:187]
    v_cvt_pk_bf16_f32 v230, v232, v233
    v_cvt_pk_bf16_f32 v231, v234, v235
    v_mfma_f32_16x16x32_bf16 v[188:191], v[40:43], a[84:87], v[188:191]
    s_nop 1
    v_permlane16_swap_b32 v228, v230
    v_mfma_f32_16x16x32_bf16 v[192:195], v[40:43], a[88:91], v[192:195]
    v_permlane16_swap_b32 v229, v231
    ds_write_b128 v86, v[228:231] offset:9216
    v_mfma_f32_16x16x32_bf16 v[196:199], v[40:43], a[92:95], v[196:199]
    v_cvt_pk_bf16_f32 v236, v236, v237
    v_cvt_pk_bf16_f32 v237, v238, v239
    v_mfma_f32_16x16x32_bf16 v[200:203], v[40:43], a[96:99], v[200:203]
    v_cvt_pk_bf16_f32 v238, v240, v241
    v_cvt_pk_bf16_f32 v239, v242, v243
    v_mfma_f32_16x16x32_bf16 v[204:207], v[40:43], a[100:103], v[204:207]
    s_nop 1
    v_permlane16_swap_b32 v236, v238
    v_mfma_f32_16x16x32_bf16 v[208:211], v[40:43], a[104:107], v[208:211]
    v_permlane16_swap_b32 v237, v239
    ds_write_b128 v86, v[236:239] offset:18432
    v_mfma_f32_16x16x32_bf16 v[212:215], v[40:43], a[108:111], v[212:215]
    v_cvt_pk_bf16_f32 v244, v244, v245
    v_cvt_pk_bf16_f32 v245, v246, v247
    v_mfma_f32_16x16x32_bf16 v[216:219], v[40:43], a[112:115], v[216:219]
    v_cvt_pk_bf16_f32 v246, v248, v249
    v_cvt_pk_bf16_f32 v247, v250, v251
    s_nop 1
    v_permlane16_swap_b32 v244, v246
    v_permlane16_swap_b32 v245, v247
    ds_write_b128 v86, v[244:247] offset:27648
    v_cvt_pk_bf16_f32 v252, v252, v253
    v_cvt_pk_bf16_f32 v253, v254, v255
    v_cvt_pk_bf16_f32 v254, v68, v69
    v_cvt_pk_bf16_f32 v255, v70, v71
    s_nop 1
    v_permlane16_swap_b32 v252, v254
    v_permlane16_swap_b32 v253, v255
    ds_write_b128 v87, v[252:255] offset:36864
    s_waitcnt lgkmcnt(0)
    s_barrier
    v_mfma_f32_16x16x32_bf16 v[148:151], v[92:95], a[40:43], v[148:151]
    ds_read_b128 a[168:171], v12 offset:4320
    v_lshlrev_b32 v52, 16, v32
    v_mfma_f32_16x16x32_bf16 v[152:155], v[92:95], a[36:39], v[152:155]
    ds_read_b128 a[172:175], v12 offset:4608
    v_lshlrev_b32 v56, 16, v33
    v_mfma_f32_16x16x32_bf16 v[156:159], v[92:95], a[0:3], v[156:159]
    ds_read_b128 a[176:179], v12 offset:4896
    v_lshlrev_b32 v60, 16, v34
    v_mfma_f32_16x16x32_bf16 v[160:163], v[92:95], a[4:7], v[160:163]
    ds_read_b128 a[180:183], v12 offset:5184
    v_lshlrev_b32 v64, 16, v35
    v_mfma_f32_16x16x32_bf16 v[164:167], v[92:95], a[8:11], v[164:167]
    ds_read_b128 a[184:187], v12 offset:5472
    v_lshlrev_b32 v53, 16, v40
    v_mfma_f32_16x16x32_bf16 v[168:171], v[92:95], a[12:15], v[168:171]
    ds_read_b128 a[188:191], v12 offset:5760
    v_lshlrev_b32 v57, 16, v41
    v_mfma_f32_16x16x32_bf16 v[172:175], v[92:95], a[16:19], v[172:175]
    ds_read_b128 a[192:195], v12 offset:6048
    v_lshlrev_b32 v61, 16, v42
    v_mfma_f32_16x16x32_bf16 v[176:179], v[92:95], a[20:23], v[176:179]
    ds_read_b128 a[196:199], v12 offset:6336
    v_lshlrev_b32 v65, 16, v43
    v_mfma_f32_16x16x32_bf16 v[180:183], v[92:95], a[24:27], v[180:183]
    ds_read_b128 a[200:203], v12 offset:6624
    v_and_b32 v54, s47, v32
    v_mfma_f32_16x16x32_bf16 v[184:187], v[96:99], a[124:127], v[184:187]
    ds_read_b128 a[204:207], v12 offset:4032
    v_and_b32 v58, s47, v33
    v_mfma_f32_16x16x32_bf16 v[188:191], v[96:99], a[120:123], v[188:191]
    ds_read_b128 a[208:211], v12 offset:3744
    s_mov_b32 m0, s61
    s_add_u32 s54, s54, s55
    v_and_b32 v62, s47, v34
    v_mfma_f32_16x16x32_bf16 v[192:195], v[96:99], a[84:87], v[192:195]
    buffer_load_dwordx4 v16, s[20:23], s54 offen lds
    v_mfma_f32_16x16x32_bf16 v[196:199], v[96:99], a[88:91], v[196:199]
    s_mov_b32 m0, s62
    s_add_u32 s54, s54, s55
    buffer_load_dwordx4 v16, s[20:23], s54 offen lds
    v_mfma_f32_16x16x32_bf16 v[200:203], v[96:99], a[92:95], v[200:203]
    s_waitcnt vmcnt(5)
    ds_read_b64_tr_b16 v[28:29], v18 offset:0
    v_and_b32 v66, s47, v35
    v_mfma_f32_16x16x32_bf16 v[204:207], v[96:99], a[96:99], v[204:207]
    ds_read_b64_tr_b16 v[30:31], v18 offset:256
    v_and_b32 v55, s47, v40
    v_mfma_f32_16x16x32_bf16 v[208:211], v[96:99], a[100:103], v[208:211]
    ds_read_b64_tr_b16 v[36:37], v18 offset:1024
    v_and_b32 v59, s47, v41
    v_mfma_f32_16x16x32_bf16 v[212:215], v[96:99], a[104:107], v[212:215]
    ds_read_b64_tr_b16 v[38:39], v18 offset:1280
    v_and_b32 v63, s47, v42
    v_mfma_f32_16x16x32_bf16 v[216:219], v[96:99], a[108:111], v[216:219]
    v_and_b32 v67, s47, v43
    v_add_f32 v52, v52, v53
    v_add_f32 v56, v56, v57
    v_add_f32 v60, v60, v61
    v_add_f32 v64, v64, v65
    v_add_f32 v54, v54, v55
    v_add_f32 v58, v58, v59
    v_add_f32 v62, v62, v63
    v_add_f32 v66, v66, v67
    v_cvt_pk_bf16_f32 v48, v52, v54
    v_cvt_pk_bf16_f32 v49, v56, v58
    v_cvt_pk_bf16_f32 v50, v60, v62
    v_cvt_pk_bf16_f32 v51, v64, v66
    v_lshlrev_b32 v52, 16, v92
    v_lshlrev_b32 v56, 16, v93
    v_lshlrev_b32 v60, 16, v94
    v_lshlrev_b32 v64, 16, v95
    v_lshlrev_b32 v53, 16, v96
    v_lshlrev_b32 v57, 16, v97
    v_lshlrev_b32 v61, 16, v98
    v_lshlrev_b32 v65, 16, v99
    s_waitcnt lgkmcnt(14)
    v_mfma_f32_16x16x32_bf16 v[220:223], v[44:47], a[168:171], 0
    ds_read_b128 a[44:47], v10 offset:3456
    v_and_b32 v54, s47, v92
    s_waitcnt lgkmcnt(14)
    v_mfma_f32_16x16x32_bf16 v[224:227], v[44:47], a[172:175], 0
    ds_read_b128 a[128:131], v11 offset:3456
    v_and_b32 v58, s47, v93
    s_waitcnt lgkmcnt(14)
    v_mfma_f32_16x16x32_bf16 v[228:231], v[44:47], a[176:179], 0
    ds_read_b128 a[212:215], v12 offset:3456
    s_waitcnt vmcnt(3)
    v_and_b32 v62, s47, v94
    s_waitcnt lgkmcnt(14)
    v_mfma_f32_16x16x32_bf16 v[232:235], v[44:47], a[180:183], 0
    ds_read_b64_tr_b16 v[32:33], v18 offset:2048
    v_and_b32 v66, s47, v95
    s_waitcnt lgkmcnt(14)
    v_mfma_f32_16x16x32_bf16 v[236:239], v[44:47], a[184:187], 0
    ds_read_b64_tr_b16 v[34:35], v18 offset:2304
    v_and_b32 v55, s47, v96
    s_waitcnt lgkmcnt(14)
    v_mfma_f32_16x16x32_bf16 v[240:243], v[44:47], a[188:191], 0
    ds_read_b64_tr_b16 v[40:41], v18 offset:3072
    v_and_b32 v59, s47, v97
    s_waitcnt lgkmcnt(14)
    v_mfma_f32_16x16x32_bf16 v[244:247], v[44:47], a[192:195], 0
    ds_read_b64_tr_b16 v[42:43], v18 offset:3328
    s_waitcnt lgkmcnt(7)
    s_mov_b32 m0, s57
    s_add_u32 s54, s54, s55
    v_and_b32 v63, s47, v98
    v_mfma_f32_16x16x32_bf16 v[248:251], v[44:47], a[196:199], 0
    buffer_load_dwordx4 v16, s[20:23], s54 offen lds
    v_mfma_f32_16x16x32_bf16 v[252:255], v[44:47], a[200:203], 0
    s_mov_b32 m0, s58
    s_add_u32 s54, s54, s55
    buffer_load_dwordx4 v16, s[20:23], s54 offen lds
    v_mfma_f32_16x16x32_bf16 v[220:223], v[48:51], a[204:207], v[220:223]
    v_and_b32 v67, s47, v99
    v_add_f32 v52, v52, v53
    v_mfma_f32_16x16x32_bf16 v[224:227], v[48:51], a[168:171], v[224:227]
    v_add_f32 v56, v56, v57
    v_add_f32 v60, v60, v61
    v_mfma_f32_16x16x32_bf16 v[228:231], v[48:51], a[172:175], v[228:231]
    v_add_f32 v64, v64, v65
    v_add_f32 v54, v54, v55
    v_mfma_f32_16x16x32_bf16 v[232:235], v[48:51], a[176:179], v[232:235]
    v_add_f32 v58, v58, v59
    v_add_f32 v62, v62, v63
    v_mfma_f32_16x16x32_bf16 v[236:239], v[48:51], a[180:183], v[236:239]
    v_add_f32 v66, v66, v67
    v_cvt_pk_bf16_f32 v144, v52, v54
    v_mfma_f32_16x16x32_bf16 v[240:243], v[48:51], a[184:187], v[240:243]
    v_cvt_pk_bf16_f32 v145, v56, v58
    v_cvt_pk_bf16_f32 v146, v60, v62
    v_mfma_f32_16x16x32_bf16 v[244:247], v[48:51], a[188:191], v[244:247]
    v_cvt_pk_bf16_f32 v147, v64, v66
    v_lshlrev_b32 v52, 16, v28
    v_mfma_f32_16x16x32_bf16 v[248:251], v[48:51], a[192:195], v[248:251]
    v_lshlrev_b32 v56, 16, v29
    v_lshlrev_b32 v60, 16, v30
    v_mfma_f32_16x16x32_bf16 v[252:255], v[48:51], a[196:199], v[252:255]
    v_lshlrev_b32 v64, 16, v31
    v_lshlrev_b32 v53, 16, v36
    v_mfma_f32_16x16x32_bf16 v[220:223], v[144:147], a[208:211], v[220:223]
    v_lshlrev_b32 v57, 16, v37
    v_lshlrev_b32 v61, 16, v38
    v_mfma_f32_16x16x32_bf16 v[224:227], v[144:147], a[204:207], v[224:227]
    v_lshlrev_b32 v65, 16, v39
    v_and_b32 v54, s47, v28
    v_mfma_f32_16x16x32_bf16 v[228:231], v[144:147], a[168:171], v[228:231]
    v_and_b32 v58, s47, v29
    v_and_b32 v62, s47, v30
    v_mfma_f32_16x16x32_bf16 v[232:235], v[144:147], a[172:175], v[232:235]
    v_and_b32 v66, s47, v31
    v_and_b32 v55, s47, v36
    v_mfma_f32_16x16x32_bf16 v[236:239], v[144:147], a[176:179], v[236:239]
    v_and_b32 v59, s47, v37
    v_and_b32 v63, s47, v38
    v_mfma_f32_16x16x32_bf16 v[240:243], v[144:147], a[180:183], v[240:243]
    v_and_b32 v67, s47, v39
    v_add_f32 v52, v52, v53
    v_mfma_f32_16x16x32_bf16 v[244:247], v[144:147], a[184:187], v[244:247]
    v_add_f32 v56, v56, v57
    v_add_f32 v60, v60, v61
    v_mfma_f32_16x16x32_bf16 v[248:251], v[144:147], a[188:191], v[248:251]
    v_add_f32 v64, v64, v65
    v_add_f32 v54, v54, v55
    v_mfma_f32_16x16x32_bf16 v[252:255], v[144:147], a[192:195], v[252:255]
    v_add_f32 v58, v58, v59
    v_add_f32 v62, v62, v63
    v_add_f32 v66, v66, v67
    v_cvt_pk_bf16_f32 v44, v52, v54
    v_cvt_pk_bf16_f32 v45, v56, v58
    v_cvt_pk_bf16_f32 v46, v60, v62
    v_cvt_pk_bf16_f32 v47, v64, v66
    v_mov_b32 v104, -1
    v_mov_b32 v105, -1
    v_mov_b32 v106, -1
    v_mov_b32 v107, -1
    s_waitcnt lgkmcnt(0)
    v_mfma_f32_16x16x32_bf16 v[148:151], v[28:31], a[44:47], v[148:151]
    s_mov_b32 m0, s59
    s_add_u32 s54, s54, s55
    buffer_load_dwordx4 v16, s[20:23], s54 offen lds
    v_mfma_f32_16x16x32_bf16 v[152:155], v[28:31], a[40:43], v[152:155]
    s_mov_b32 m0, s60
    s_add_u32 s54, s54, s55
    buffer_load_dwordx4 v16, s[20:23], s54 offen lds
    v_mfma_f32_16x16x32_bf16 v[156:159], v[28:31], a[36:39], v[156:159]
    s_waitcnt vmcnt(4)
    ds_read_b64_tr_b16 v[92:93], v18 offset:4096
    v_lshlrev_b32 v52, 16, v32
    v_mfma_f32_16x16x32_bf16 v[160:163], v[28:31], a[0:3], v[160:163]
    ds_read_b64_tr_b16 v[94:95], v18 offset:4352
    v_lshlrev_b32 v56, 16, v33
    v_mfma_f32_16x16x32_bf16 v[164:167], v[28:31], a[4:7], v[164:167]
    ds_read_b64_tr_b16 v[96:97], v18 offset:5120
    v_lshlrev_b32 v60, 16, v34
    v_mfma_f32_16x16x32_bf16 v[168:171], v[28:31], a[8:11], v[168:171]
    ds_read_b64_tr_b16 v[98:99], v18 offset:5376
    v_lshlrev_b32 v64, 16, v35
    v_mfma_f32_16x16x32_bf16 v[172:175], v[28:31], a[12:15], v[172:175]
    ds_read_b128 a[48:51], v10 offset:3168
    v_lshlrev_b32 v53, 16, v40
    v_mfma_f32_16x16x32_bf16 v[176:179], v[28:31], a[16:19], v[176:179]
    ds_read_b128 a[132:135], v11 offset:3168
    v_lshlrev_b32 v57, 16, v41
    v_mfma_f32_16x16x32_bf16 v[180:183], v[28:31], a[20:23], v[180:183]
    ds_read_b128 a[216:219], v12 offset:3168
    v_lshlrev_b32 v61, 16, v42
    v_mfma_f32_16x16x32_bf16 v[184:187], v[36:39], a[128:131], v[184:187]
    ds_read_b128 v[76:79], v19 offset:64
    v_lshlrev_b32 v65, 16, v43
    v_mfma_f32_16x16x32_bf16 v[188:191], v[36:39], a[124:127], v[188:191]
    ds_read_b128 v[80:83], v19 offset:4672
    v_and_b32 v54, s47, v32
    v_mfma_f32_16x16x32_bf16 v[192:195], v[36:39], a[120:123], v[192:195]
    v_and_b32 v58, s47, v33
    v_and_b32 v62, s47, v34
    v_mfma_f32_16x16x32_bf16 v[196:199], v[36:39], a[84:87], v[196:199]
    v_and_b32 v66, s47, v35
    v_and_b32 v55, s47, v40
    v_mfma_f32_16x16x32_bf16 v[200:203], v[36:39], a[88:91], v[200:203]
    v_and_b32 v59, s47, v41
    v_and_b32 v63, s47, v42
    v_mfma_f32_16x16x32_bf16 v[204:207], v[36:39], a[92:95], v[204:207]
    v_and_b32 v67, s47, v43
    v_add_f32 v52, v52, v53
    v_mfma_f32_16x16x32_bf16 v[208:211], v[36:39], a[96:99], v[208:211]
    v_add_f32 v56, v56, v57
    v_add_f32 v60, v60, v61
    v_mfma_f32_16x16x32_bf16 v[212:215], v[36:39], a[100:103], v[212:215]
    v_add_f32 v64, v64, v65
    v_add_f32 v54, v54, v55
    v_mfma_f32_16x16x32_bf16 v[216:219], v[36:39], a[104:107], v[216:219]
    v_add_f32 v58, v58, v59
    v_add_f32 v62, v62, v63
    v_mfma_f32_16x16x32_bf16 v[220:223], v[44:47], a[212:215], v[220:223]
    v_add_f32 v66, v66, v67
    v_cvt_pk_bf16_f32 v48, v52, v54
    v_mfma_f32_16x16x32_bf16 v[224:227], v[44:47], a[208:211], v[224:227]
    v_cvt_pk_bf16_f32 v49, v56, v58
    v_cvt_pk_bf16_f32 v50, v60, v62
    v_mfma_f32_16x16x32_bf16 v[228:231], v[44:47], a[204:207], v[228:231]
    v_cvt_pk_bf16_f32 v51, v64, v66
    v_mfma_f32_16x16x32_bf16 v[232:235], v[44:47], a[168:171], v[232:235]
    v_mfma_f32_16x16x32_bf16 v[236:239], v[44:47], a[172:175], v[236:239]
    v_mfma_f32_16x16x32_bf16 v[240:243], v[44:47], a[176:179], v[240:243]
    v_mfma_f32_16x16x32_bf16 v[244:247], v[44:47], a[180:183], v[244:247]
    v_mfma_f32_16x16x32_bf16 v[248:251], v[44:47], a[184:187], v[248:251]
    v_mfma_f32_16x16x32_bf16 v[252:255], v[44:47], a[188:191], v[252:255]
    s_waitcnt lgkmcnt(2)
    v_mfma_f32_16x16x32_bf16 v[148:151], v[32:35], a[48:51], v[148:151]
    s_mov_b32 m0, s61
    s_add_u32 s54, s54, s55
    buffer_load_dwordx4 v16, s[20:23], s54 offen lds
    v_mfma_f32_16x16x32_bf16 v[152:155], v[32:35], a[44:47], v[152:155]
    s_mov_b32 m0, s62
    s_add_u32 s54, s54, s55
    buffer_load_dwordx4 v16, s[20:23], s54 offen lds
    v_mfma_f32_16x16x32_bf16 v[156:159], v[32:35], a[40:43], v[156:159]
    s_waitcnt lgkmcnt(1)
    v_mfma_f32_16x16x32_bf16 v[68:71], v[24:27], v[76:79], 0
    v_lshlrev_b32 v52, 16, v92
    v_lshlrev_b32 v56, 16, v93
    v_mfma_f32_16x16x32_bf16 v[160:163], v[32:35], a[36:39], v[160:163]
    s_waitcnt lgkmcnt(0)
    v_mfma_f32_16x16x32_bf16 v[72:75], v[24:27], v[80:83], 0
    s_waitcnt vmcnt(4)
    ds_read_b64_tr_b16 v[28:29], v18 offset:0
    v_lshlrev_b32 v60, 16, v94
    v_mfma_f32_16x16x32_bf16 v[164:167], v[32:35], a[0:3], v[164:167]
    ds_read_b64_tr_b16 v[30:31], v18 offset:256
    v_lshlrev_b32 v64, 16, v95
    v_mfma_f32_16x16x32_bf16 v[168:171], v[32:35], a[4:7], v[168:171]
    ds_read_b64_tr_b16 v[36:37], v18 offset:1024
    v_lshlrev_b32 v53, 16, v96
    v_mfma_f32_16x16x32_bf16 v[172:175], v[32:35], a[8:11], v[172:175]
    ds_read_b64_tr_b16 v[38:39], v18 offset:1280
    v_lshlrev_b32 v57, 16, v97
    v_mfma_f32_16x16x32_bf16 v[176:179], v[32:35], a[12:15], v[176:179]
    ds_read_b128 a[52:55], v10 offset:2880
    v_lshlrev_b32 v61, 16, v98
    v_mfma_f32_16x16x32_bf16 v[180:183], v[32:35], a[16:19], v[180:183]
    ds_read_b128 a[136:139], v11 offset:2880
    v_lshlrev_b32 v65, 16, v99
    v_mfma_f32_16x16x32_bf16 v[184:187], v[40:43], a[132:135], v[184:187]
    ds_read_b128 a[220:223], v12 offset:2880
    s_mov_b32 s100, 1990656
    v_and_b32 v54, s47, v92
    v_mfma_f32_16x16x32_bf16 v[188:191], v[40:43], a[128:131], v[188:191]
    buffer_load_dword v21, v0, s[20:23], s100 offen
    v_mfma_f32_16x16x32_bf16 v[192:195], v[40:43], a[124:127], v[192:195]
    ds_read_b128 v[76:79], v19 offset:9280
    v_and_b32 v58, s47, v93
    v_mfma_f32_16x16x32_bf16 v[196:199], v[40:43], a[120:123], v[196:199]
    v_cvt_pk_bf16_f32 v84, v68, v69
    v_cvt_pk_bf16_f32 v85, v70, v71
    v_mfma_f32_16x16x32_bf16 v[200:203], v[40:43], a[84:87], v[200:203]
    v_cvt_pk_bf16_f32 v86, v72, v73
    v_cvt_pk_bf16_f32 v87, v74, v75
    v_mfma_f32_16x16x32_bf16 v[204:207], v[40:43], a[88:91], v[204:207]
    ds_write_b64 v20, v[84:85] offset:64
    ds_write_b64 v20, v[86:87] offset:4672
    v_mfma_f32_16x16x32_bf16 v[208:211], v[40:43], a[92:95], v[208:211]
    v_and_b32 v62, s47, v94
    v_and_b32 v66, s47, v95
    v_mfma_f32_16x16x32_bf16 v[212:215], v[40:43], a[96:99], v[212:215]
    v_and_b32 v55, s47, v96
    v_and_b32 v59, s47, v97
    v_mfma_f32_16x16x32_bf16 v[216:219], v[40:43], a[100:103], v[216:219]
    v_and_b32 v63, s47, v98
    v_and_b32 v67, s47, v99
    v_mfma_f32_16x16x32_bf16 v[220:223], v[48:51], a[216:219], v[220:223]
    v_add_f32 v52, v52, v53
    v_add_f32 v56, v56, v57
    v_mfma_f32_16x16x32_bf16 v[224:227], v[48:51], a[212:215], v[224:227]
    v_add_f32 v60, v60, v61
    v_add_f32 v64, v64, v65
    v_mfma_f32_16x16x32_bf16 v[228:231], v[48:51], a[208:211], v[228:231]
    v_add_f32 v54, v54, v55
    v_add_f32 v58, v58, v59
    v_mfma_f32_16x16x32_bf16 v[232:235], v[48:51], a[204:207], v[232:235]
    v_add_f32 v62, v62, v63
    v_add_f32 v66, v66, v67
    v_mfma_f32_16x16x32_bf16 v[236:239], v[48:51], a[168:171], v[236:239]
    v_cvt_pk_bf16_f32 v144, v52, v54
    v_cvt_pk_bf16_f32 v145, v56, v58
    v_mfma_f32_16x16x32_bf16 v[240:243], v[48:51], a[172:175], v[240:243]
    v_cvt_pk_bf16_f32 v146, v60, v62
    v_cvt_pk_bf16_f32 v147, v64, v66
    v_mfma_f32_16x16x32_bf16 v[244:247], v[48:51], a[176:179], v[244:247]
    v_mfma_f32_16x16x32_bf16 v[248:251], v[48:51], a[180:183], v[248:251]
    v_mfma_f32_16x16x32_bf16 v[252:255], v[48:51], a[184:187], v[252:255]
    s_waitcnt lgkmcnt(3)
    v_mfma_f32_16x16x32_bf16 v[148:151], v[92:95], a[52:55], v[148:151]
    s_mov_b32 m0, s57
    s_add_u32 s54, s54, s55
    buffer_load_dwordx4 v16, s[20:23], s54 offen lds
    v_mfma_f32_16x16x32_bf16 v[152:155], v[92:95], a[48:51], v[152:155]
    s_mov_b32 m0, s58
    s_add_u32 s54, s54, s55
    buffer_load_dwordx4 v16, s[20:23], s54 offen lds
    v_mfma_f32_16x16x32_bf16 v[156:159], v[92:95], a[44:47], v[156:159]
    s_waitcnt lgkmcnt(2)
    v_mfma_f32_16x16x32_bf16 v[68:71], v[24:27], v[76:79], 0
    s_waitcnt vmcnt(5)
    ds_read_b64_tr_b16 v[32:33], v18 offset:2048
    v_lshlrev_b32 v52, 16, v28
    v_mfma_f32_16x16x32_bf16 v[160:163], v[92:95], a[40:43], v[160:163]
    ds_read_b64_tr_b16 v[34:35], v18 offset:2304
    v_lshlrev_b32 v56, 16, v29
    v_mfma_f32_16x16x32_bf16 v[164:167], v[92:95], a[36:39], v[164:167]
    ds_read_b64_tr_b16 v[40:41], v18 offset:3072
    v_lshlrev_b32 v60, 16, v30
    v_mfma_f32_16x16x32_bf16 v[168:171], v[92:95], a[0:3], v[168:171]
    ds_read_b64_tr_b16 v[42:43], v18 offset:3328
    v_lshlrev_b32 v64, 16, v31
    v_mfma_f32_16x16x32_bf16 v[172:175], v[92:95], a[4:7], v[172:175]
    ds_read_b128 a[56:59], v10 offset:2592
    v_lshlrev_b32 v53, 16, v36
    v_mfma_f32_16x16x32_bf16 v[176:179], v[92:95], a[8:11], v[176:179]
    ds_read_b128 a[140:143], v11 offset:2592
    v_lshlrev_b32 v57, 16, v37
    v_mfma_f32_16x16x32_bf16 v[180:183], v[92:95], a[12:15], v[180:183]
    ds_read_b128 a[224:227], v12 offset:2592
    v_lshlrev_b32 v61, 16, v38
    v_mfma_f32_16x16x32_bf16 v[184:187], v[96:99], a[136:139], v[184:187]
    ds_read_b128 a[60:63], v10 offset:4384
    v_lshlrev_b32 v65, 16, v39
    v_mfma_f32_16x16x32_bf16 v[188:191], v[96:99], a[132:135], v[188:191]
    ds_read_b128 a[64:67], v10 offset:4672
    v_and_b32 v54, s47, v28
    v_mfma_f32_16x16x32_bf16 v[192:195], v[96:99], a[128:131], v[192:195]
    ds_read_b128 v[80:83], v19 offset:13888
    v_and_b32 v58, s47, v29
    v_mfma_f32_16x16x32_bf16 v[196:199], v[96:99], a[124:127], v[196:199]
    v_cvt_pk_bf16_f32 v84, v68, v69
    v_cvt_pk_bf16_f32 v85, v70, v71
    v_mfma_f32_16x16x32_bf16 v[200:203], v[96:99], a[120:123], v[200:203]
    ds_write_b64 v20, v[84:85] offset:9280
    v_and_b32 v62, s47, v30
    v_mfma_f32_16x16x32_bf16 v[204:207], v[96:99], a[84:87], v[204:207]
    v_and_b32 v66, s47, v31
    v_and_b32 v55, s47, v36
    v_mfma_f32_16x16x32_bf16 v[208:211], v[96:99], a[88:91], v[208:211]
    v_and_b32 v59, s47, v37
    v_and_b32 v63, s47, v38
    v_mfma_f32_16x16x32_bf16 v[212:215], v[96:99], a[92:95], v[212:215]
    v_and_b32 v67, s47, v39
    v_add_f32 v52, v52, v53
    v_mfma_f32_16x16x32_bf16 v[216:219], v[96:99], a[96:99], v[216:219]
    v_add_f32 v56, v56, v57
    v_add_f32 v60, v60, v61
    v_mfma_f32_16x16x32_bf16 v[220:223], v[144:147], a[220:223], v[220:223]
    v_add_f32 v64, v64, v65
    v_add_f32 v54, v54, v55
    v_mfma_f32_16x16x32_bf16 v[224:227], v[144:147], a[216:219], v[224:227]
    v_add_f32 v58, v58, v59
    v_add_f32 v62, v62, v63
    v_mfma_f32_16x16x32_bf16 v[228:231], v[144:147], a[212:215], v[228:231]
    v_add_f32 v66, v66, v67
    v_cvt_pk_bf16_f32 v44, v52, v54
    v_mfma_f32_16x16x32_bf16 v[232:235], v[144:147], a[208:211], v[232:235]
    v_cvt_pk_bf16_f32 v45, v56, v58
    v_cvt_pk_bf16_f32 v46, v60, v62
    v_mfma_f32_16x16x32_bf16 v[236:239], v[144:147], a[204:207], v[236:239]
    v_cvt_pk_bf16_f32 v47, v64, v66
    v_mfma_f32_16x16x32_bf16 v[240:243], v[144:147], a[168:171], v[240:243]
    v_mfma_f32_16x16x32_bf16 v[244:247], v[144:147], a[172:175], v[244:247]
    v_mfma_f32_16x16x32_bf16 v[248:251], v[144:147], a[176:179], v[248:251]
    v_mfma_f32_16x16x32_bf16 v[252:255], v[144:147], a[180:183], v[252:255]
    s_waitcnt lgkmcnt(4)
    v_mfma_f32_16x16x32_bf16 v[148:151], v[28:31], a[56:59], v[148:151]
    s_mov_b32 m0, s59
    s_add_u32 s54, s54, s55
    buffer_load_dwordx4 v16, s[20:23], s54 offen lds
    v_mfma_f32_16x16x32_bf16 v[152:155], v[28:31], a[52:55], v[152:155]
    s_mov_b32 m0, s60
    s_add_u32 s54, s54, s55
    buffer_load_dwordx4 v16, s[20:23], s54 offen lds
    v_mfma_f32_16x16x32_bf16 v[156:159], v[28:31], a[48:51], v[156:159]
    s_waitcnt lgkmcnt(1)
    v_mfma_f32_16x16x32_bf16 v[72:75], v[24:27], v[80:83], 0
    s_waitcnt vmcnt(5)
    ds_read_b64_tr_b16 v[92:93], v18 offset:4096
    v_lshlrev_b32 v52, 16, v32
    v_mfma_f32_16x16x32_bf16 v[160:163], v[28:31], a[44:47], v[160:163]
    ds_read_b64_tr_b16 v[94:95], v18 offset:4352
    v_lshlrev_b32 v56, 16, v33
    v_mfma_f32_16x16x32_bf16 v[164:167], v[28:31], a[40:43], v[164:167]
    ds_read_b64_tr_b16 v[96:97], v18 offset:5120
    v_lshlrev_b32 v60, 16, v34
    v_mfma_f32_16x16x32_bf16 v[168:171], v[28:31], a[36:39], v[168:171]
    ds_read_b64_tr_b16 v[98:99], v18 offset:5376
    v_lshlrev_b32 v64, 16, v35
    v_mfma_f32_16x16x32_bf16 v[172:175], v[28:31], a[0:3], v[172:175]
    ds_read_b128 a[68:71], v10 offset:2304
    v_lshlrev_b32 v53, 16, v40
    v_mfma_f32_16x16x32_bf16 v[176:179], v[28:31], a[4:7], v[176:179]
    ds_read_b128 a[144:147], v11 offset:2304
    v_lshlrev_b32 v57, 16, v41
    v_mfma_f32_16x16x32_bf16 v[180:183], v[28:31], a[8:11], v[180:183]
    ds_read_b128 a[228:231], v12 offset:2304
    v_lshlrev_b32 v61, 16, v42
    v_mfma_f32_16x16x32_bf16 v[184:187], v[36:39], a[140:143], v[184:187]
    ds_read_b128 a[72:75], v10 offset:4960
    v_lshlrev_b32 v65, 16, v43
    v_mfma_f32_16x16x32_bf16 v[188:191], v[36:39], a[136:139], v[188:191]
    ds_read_b128 a[76:79], v10 offset:5248
    s_mov_b32 s51, 0
    v_and_b32 v54, s47, v32
    v_mfma_f32_16x16x32_bf16 v[192:195], v[36:39], a[132:135], v[192:195]
    buffer_store_dwordx4 v[104:107], v100, s[32:35], s51 offen sc1
    v_mfma_f32_16x16x32_bf16 v[196:199], v[36:39], a[128:131], v[196:199]
    ds_read_b128 v[76:79], v19 offset:18496
    v_and_b32 v58, s47, v33
    v_mfma_f32_16x16x32_bf16 v[200:203], v[36:39], a[124:127], v[200:203]
    v_cvt_pk_bf16_f32 v86, v72, v73
    v_cvt_pk_bf16_f32 v87, v74, v75
    v_mfma_f32_16x16x32_bf16 v[204:207], v[36:39], a[120:123], v[204:207]
    ds_write_b64 v20, v[86:87] offset:13888
    v_and_b32 v62, s47, v34
    v_mfma_f32_16x16x32_bf16 v[208:211], v[36:39], a[84:87], v[208:211]
    v_and_b32 v66, s47, v35
    v_and_b32 v55, s47, v40
    v_mfma_f32_16x16x32_bf16 v[212:215], v[36:39], a[88:91], v[212:215]
    v_and_b32 v59, s47, v41
    v_and_b32 v63, s47, v42
    v_mfma_f32_16x16x32_bf16 v[216:219], v[36:39], a[92:95], v[216:219]
    v_and_b32 v67, s47, v43
    v_add_f32 v52, v52, v53
    v_mfma_f32_16x16x32_bf16 v[220:223], v[44:47], a[224:227], v[220:223]
    v_add_f32 v56, v56, v57
    v_add_f32 v60, v60, v61
    v_mfma_f32_16x16x32_bf16 v[224:227], v[44:47], a[220:223], v[224:227]
    v_add_f32 v64, v64, v65
    v_add_f32 v54, v54, v55
    v_mfma_f32_16x16x32_bf16 v[228:231], v[44:47], a[216:219], v[228:231]
    v_add_f32 v58, v58, v59
    v_add_f32 v62, v62, v63
    v_mfma_f32_16x16x32_bf16 v[232:235], v[44:47], a[212:215], v[232:235]
    v_add_f32 v66, v66, v67
    v_cvt_pk_bf16_f32 v48, v52, v54
    v_mfma_f32_16x16x32_bf16 v[236:239], v[44:47], a[208:211], v[236:239]
    v_cvt_pk_bf16_f32 v49, v56, v58
    v_cvt_pk_bf16_f32 v50, v60, v62
    v_mfma_f32_16x16x32_bf16 v[240:243], v[44:47], a[204:207], v[240:243]
    v_cvt_pk_bf16_f32 v51, v64, v66
    v_mfma_f32_16x16x32_bf16 v[244:247], v[44:47], a[168:171], v[244:247]
    v_mfma_f32_16x16x32_bf16 v[248:251], v[44:47], a[172:175], v[248:251]
    v_mfma_f32_16x16x32_bf16 v[252:255], v[44:47], a[176:179], v[252:255]
    s_waitcnt lgkmcnt(4)
    v_mfma_f32_16x16x32_bf16 v[148:151], v[32:35], a[68:71], v[148:151]
    s_mov_b32 m0, s61
    s_add_u32 s54, s54, s55
    buffer_load_dwordx4 v16, s[20:23], s54 offen lds
    v_mfma_f32_16x16x32_bf16 v[152:155], v[32:35], a[56:59], v[152:155]
    s_mov_b32 m0, s62
    s_add_u32 s54, s54, s55
    buffer_load_dwordx4 v16, s[20:23], s54 offen lds
    v_mfma_f32_16x16x32_bf16 v[156:159], v[32:35], a[52:55], v[156:159]
    s_waitcnt lgkmcnt(1)
    v_mfma_f32_16x16x32_bf16 v[68:71], v[24:27], v[76:79], 0
    s_waitcnt vmcnt(5)
    ds_read_b64_tr_b16 v[28:29], v18 offset:0
    v_lshlrev_b32 v52, 16, v92
    v_mfma_f32_16x16x32_bf16 v[160:163], v[32:35], a[48:51], v[160:163]
    ds_read_b64_tr_b16 v[30:31], v18 offset:256
    v_lshlrev_b32 v56, 16, v93
    v_mfma_f32_16x16x32_bf16 v[164:167], v[32:35], a[44:47], v[164:167]
    ds_read_b64_tr_b16 v[36:37], v18 offset:1024
    v_lshlrev_b32 v60, 16, v94
    v_mfma_f32_16x16x32_bf16 v[168:171], v[32:35], a[40:43], v[168:171]
    ds_read_b64_tr_b16 v[38:39], v18 offset:1280
    v_lshlrev_b32 v64, 16, v95
    v_mfma_f32_16x16x32_bf16 v[172:175], v[32:35], a[36:39], v[172:175]
    ds_read_b128 a[80:83], v10 offset:2016
    v_lshlrev_b32 v53, 16, v96
    v_mfma_f32_16x16x32_bf16 v[176:179], v[32:35], a[0:3], v[176:179]
    ds_read_b128 a[148:151], v11 offset:2016
    v_lshlrev_b32 v57, 16, v97
    v_mfma_f32_16x16x32_bf16 v[180:183], v[32:35], a[4:7], v[180:183]
    ds_read_b128 a[232:235], v12 offset:2016
    v_lshlrev_b32 v61, 16, v98
    v_mfma_f32_16x16x32_bf16 v[184:187], v[40:43], a[144:147], v[184:187]
    ds_read_b128 a[32:35], v10 offset:5536
    v_lshlrev_b32 v65, 16, v99
    v_mfma_f32_16x16x32_bf16 v[188:191], v[40:43], a[140:143], v[188:191]
    ds_read_b128 a[28:31], v10 offset:5824
    v_and_b32 v54, s47, v92
    v_mfma_f32_16x16x32_bf16 v[192:195], v[40:43], a[136:139], v[192:195]
    ds_read_b128 v[80:83], v19 offset:23104
    v_and_b32 v58, s47, v93
    v_mfma_f32_16x16x32_bf16 v[196:199], v[40:43], a[132:135], v[196:199]
    v_cvt_pk_bf16_f32 v84, v68, v69
    v_cvt_pk_bf16_f32 v85, v70, v71
    v_mfma_f32_16x16x32_bf16 v[200:203], v[40:43], a[128:131], v[200:203]
    ds_write_b64 v20, v[84:85] offset:18496
    v_and_b32 v62, s47, v94
    v_mfma_f32_16x16x32_bf16 v[204:207], v[40:43], a[124:127], v[204:207]
    v_and_b32 v66, s47, v95
    v_and_b32 v55, s47, v96
    v_mfma_f32_16x16x32_bf16 v[208:211], v[40:43], a[120:123], v[208:211]
    v_and_b32 v59, s47, v97
    v_and_b32 v63, s47, v98
    v_mfma_f32_16x16x32_bf16 v[212:215], v[40:43], a[84:87], v[212:215]
    v_and_b32 v67, s47, v99
    v_add_f32 v52, v52, v53
    v_mfma_f32_16x16x32_bf16 v[216:219], v[40:43], a[88:91], v[216:219]
    v_add_f32 v56, v56, v57
    v_add_f32 v60, v60, v61
    v_mfma_f32_16x16x32_bf16 v[220:223], v[48:51], a[228:231], v[220:223]
    v_add_f32 v64, v64, v65
    v_add_f32 v54, v54, v55
    v_mfma_f32_16x16x32_bf16 v[224:227], v[48:51], a[224:227], v[224:227]
    v_add_f32 v58, v58, v59
    v_add_f32 v62, v62, v63
    v_mfma_f32_16x16x32_bf16 v[228:231], v[48:51], a[220:223], v[228:231]
    v_add_f32 v66, v66, v67
    v_cvt_pk_bf16_f32 v144, v52, v54
    v_mfma_f32_16x16x32_bf16 v[232:235], v[48:51], a[216:219], v[232:235]
    v_cvt_pk_bf16_f32 v145, v56, v58
    v_cvt_pk_bf16_f32 v146, v60, v62
    v_mfma_f32_16x16x32_bf16 v[236:239], v[48:51], a[212:215], v[236:239]
    v_cvt_pk_bf16_f32 v147, v64, v66
    v_mfma_f32_16x16x32_bf16 v[240:243], v[48:51], a[208:211], v[240:243]
    v_mfma_f32_16x16x32_bf16 v[244:247], v[48:51], a[204:207], v[244:247]
    v_mfma_f32_16x16x32_bf16 v[248:251], v[48:51], a[168:171], v[248:251]
    v_mfma_f32_16x16x32_bf16 v[252:255], v[48:51], a[172:175], v[252:255]
    s_waitcnt lgkmcnt(4)
    v_mfma_f32_16x16x32_bf16 v[148:151], v[92:95], a[80:83], v[148:151]
    s_mov_b32 m0, s57
    s_add_u32 s54, s54, s55
    buffer_load_dwordx4 v16, s[20:23], s54 offen lds
    v_mfma_f32_16x16x32_bf16 v[152:155], v[92:95], a[68:71], v[152:155]
    s_mov_b32 m0, s58
    s_add_u32 s54, s54, s55
    buffer_load_dwordx4 v16, s[20:23], s54 offen lds
    v_mfma_f32_16x16x32_bf16 v[156:159], v[92:95], a[56:59], v[156:159]
    s_waitcnt lgkmcnt(1)
    v_mfma_f32_16x16x32_bf16 v[72:75], v[24:27], v[80:83], 0
    s_waitcnt vmcnt(5)
    ds_read_b64_tr_b16 v[32:33], v18 offset:2048
    v_lshlrev_b32 v52, 16, v28
    v_mfma_f32_16x16x32_bf16 v[160:163], v[92:95], a[52:55], v[160:163]
    ds_read_b64_tr_b16 v[34:35], v18 offset:2304
    v_lshlrev_b32 v56, 16, v29
    v_mfma_f32_16x16x32_bf16 v[164:167], v[92:95], a[48:51], v[164:167]
    ds_read_b64_tr_b16 v[40:41], v18 offset:3072
    v_lshlrev_b32 v60, 16, v30
    v_mfma_f32_16x16x32_bf16 v[168:171], v[92:95], a[44:47], v[168:171]
    ds_read_b64_tr_b16 v[42:43], v18 offset:3328
    v_lshlrev_b32 v64, 16, v31
    v_mfma_f32_16x16x32_bf16 v[172:175], v[92:95], a[40:43], v[172:175]
    ds_read_b128 a[24:27], v10 offset:1728
    v_lshlrev_b32 v53, 16, v36
    v_mfma_f32_16x16x32_bf16 v[176:179], v[92:95], a[36:39], v[176:179]
    ds_read_b128 a[152:155], v11 offset:1728
    v_lshlrev_b32 v57, 16, v37
    v_mfma_f32_16x16x32_bf16 v[180:183], v[92:95], a[0:3], v[180:183]
    ds_read_b128 a[236:239], v12 offset:1728
    v_lshlrev_b32 v61, 16, v38
    v_mfma_f32_16x16x32_bf16 v[184:187], v[96:99], a[148:151], v[184:187]
    ds_read_b128 a[20:23], v10 offset:6112
    v_lshlrev_b32 v65, 16, v39
    v_mfma_f32_16x16x32_bf16 v[188:191], v[96:99], a[144:147], v[188:191]
    ds_read_b128 a[16:19], v10 offset:6400
    s_mov_b32 s100, 18432
    v_and_b32 v54, s47, v28
    v_mfma_f32_16x16x32_bf16 v[192:195], v[96:99], a[140:143], v[192:195]
    buffer_load_dword v21, v0, s[20:23], s100 offen
    v_mfma_f32_16x16x32_bf16 v[196:199], v[96:99], a[136:139], v[196:199]
    ds_read_b128 v[76:79], v19 offset:27712
    v_and_b32 v58, s47, v29
    v_mfma_f32_16x16x32_bf16 v[200:203], v[96:99], a[132:135], v[200:203]
    v_cvt_pk_bf16_f32 v86, v72, v73
    v_cvt_pk_bf16_f32 v87, v74, v75
    v_mfma_f32_16x16x32_bf16 v[204:207], v[96:99], a[128:131], v[204:207]
    ds_write_b64 v20, v[86:87] offset:23104
    v_and_b32 v62, s47, v30
    v_mfma_f32_16x16x32_bf16 v[208:211], v[96:99], a[124:127], v[208:211]
    v_and_b32 v66, s47, v31
    v_and_b32 v55, s47, v36
    v_mfma_f32_16x16x32_bf16 v[212:215], v[96:99], a[120:123], v[212:215]
    v_and_b32 v59, s47, v37
    v_and_b32 v63, s47, v38
    v_mfma_f32_16x16x32_bf16 v[216:219], v[96:99], a[84:87], v[216:219]
    v_and_b32 v67, s47, v39
    v_add_f32 v52, v52, v53
    v_mfma_f32_16x16x32_bf16 v[220:223], v[144:147], a[232:235], v[220:223]
    v_add_f32 v56, v56, v57
    v_add_f32 v60, v60, v61
    v_mfma_f32_16x16x32_bf16 v[224:227], v[144:147], a[228:231], v[224:227]
    v_add_f32 v64, v64, v65
    v_add_f32 v54, v54, v55
    v_mfma_f32_16x16x32_bf16 v[228:231], v[144:147], a[224:227], v[228:231]
    v_add_f32 v58, v58, v59
    v_add_f32 v62, v62, v63
    v_mfma_f32_16x16x32_bf16 v[232:235], v[144:147], a[220:223], v[232:235]
    v_add_f32 v66, v66, v67
    v_cvt_pk_bf16_f32 v44, v52, v54
    v_mfma_f32_16x16x32_bf16 v[236:239], v[144:147], a[216:219], v[236:239]
    v_cvt_pk_bf16_f32 v45, v56, v58
    v_cvt_pk_bf16_f32 v46, v60, v62
    v_mfma_f32_16x16x32_bf16 v[240:243], v[144:147], a[212:215], v[240:243]
    v_cvt_pk_bf16_f32 v47, v64, v66
    v_mfma_f32_16x16x32_bf16 v[244:247], v[144:147], a[208:211], v[244:247]
    v_mfma_f32_16x16x32_bf16 v[248:251], v[144:147], a[204:207], v[248:251]
    v_mfma_f32_16x16x32_bf16 v[252:255], v[144:147], a[168:171], v[252:255]
    s_waitcnt lgkmcnt(4)
    v_mfma_f32_16x16x32_bf16 v[148:151], v[28:31], a[24:27], v[148:151]
    s_mov_b32 m0, s59
    s_add_u32 s54, s54, s55
    buffer_load_dwordx4 v16, s[20:23], s54 offen lds
    v_mfma_f32_16x16x32_bf16 v[152:155], v[28:31], a[80:83], v[152:155]
    s_mov_b32 m0, s60
    s_add_u32 s54, s54, s55
    buffer_load_dwordx4 v16, s[20:23], s54 offen lds
    v_mfma_f32_16x16x32_bf16 v[156:159], v[28:31], a[68:71], v[156:159]
    s_waitcnt lgkmcnt(1)
    v_mfma_f32_16x16x32_bf16 v[68:71], v[24:27], v[76:79], 0
    s_waitcnt vmcnt(5)
    ds_read_b64_tr_b16 v[92:93], v18 offset:4096
    v_lshlrev_b32 v52, 16, v32
    v_mfma_f32_16x16x32_bf16 v[160:163], v[28:31], a[56:59], v[160:163]
    ds_read_b64_tr_b16 v[94:95], v18 offset:4352
    v_lshlrev_b32 v56, 16, v33
    v_mfma_f32_16x16x32_bf16 v[164:167], v[28:31], a[52:55], v[164:167]
    ds_read_b64_tr_b16 v[96:97], v18 offset:5120
    v_lshlrev_b32 v60, 16, v34
    v_mfma_f32_16x16x32_bf16 v[168:171], v[28:31], a[48:51], v[168:171]
    ds_read_b64_tr_b16 v[98:99], v18 offset:5376
    v_lshlrev_b32 v64, 16, v35
    v_mfma_f32_16x16x32_bf16 v[172:175], v[28:31], a[44:47], v[172:175]
    ds_read_b128 a[12:15], v10 offset:1440
    v_lshlrev_b32 v53, 16, v40
    v_mfma_f32_16x16x32_bf16 v[176:179], v[28:31], a[40:43], v[176:179]
    ds_read_b128 a[156:159], v11 offset:1440
    v_lshlrev_b32 v57, 16, v41
    v_mfma_f32_16x16x32_bf16 v[180:183], v[28:31], a[36:39], v[180:183]
    ds_read_b128 a[240:243], v12 offset:1440
    v_lshlrev_b32 v61, 16, v42
    v_mfma_f32_16x16x32_bf16 v[184:187], v[36:39], a[152:155], v[184:187]
    ds_read_b128 a[8:11], v10 offset:6688
    v_lshlrev_b32 v65, 16, v43
    v_mfma_f32_16x16x32_bf16 v[188:191], v[36:39], a[148:151], v[188:191]
    ds_read_b128 v[80:83], v19 offset:32320
    v_and_b32 v54, s47, v32
    v_mfma_f32_16x16x32_bf16 v[192:195], v[36:39], a[144:147], v[192:195]
    v_and_b32 v58, s47, v33
    v_cvt_pk_bf16_f32 v84, v68, v69
    v_mfma_f32_16x16x32_bf16 v[196:199], v[36:39], a[140:143], v[196:199]
    v_cvt_pk_bf16_f32 v85, v70, v71
    ds_write_b64 v20, v[84:85] offset:27712
    v_mfma_f32_16x16x32_bf16 v[200:203], v[36:39], a[136:139], v[200:203]
    v_and_b32 v62, s47, v34
    v_and_b32 v66, s47, v35
    v_mfma_f32_16x16x32_bf16 v[204:207], v[36:39], a[132:135], v[204:207]
    v_and_b32 v55, s47, v40
    v_and_b32 v59, s47, v41
    v_mfma_f32_16x16x32_bf16 v[208:211], v[36:39], a[128:131], v[208:211]
    v_and_b32 v63, s47, v42
    v_and_b32 v67, s47, v43
    v_mfma_f32_16x16x32_bf16 v[212:215], v[36:39], a[124:127], v[212:215]
    v_add_f32 v52, v52, v53
    v_add_f32 v56, v56, v57
    v_mfma_f32_16x16x32_bf16 v[216:219], v[36:39], a[120:123], v[216:219]
    v_add_f32 v60, v60, v61
    v_add_f32 v64, v64, v65
    v_mfma_f32_16x16x32_bf16 v[220:223], v[44:47], a[236:239], v[220:223]
    v_add_f32 v54, v54, v55
    v_add_f32 v58, v58, v59
    v_mfma_f32_16x16x32_bf16 v[224:227], v[44:47], a[232:235], v[224:227]
    v_add_f32 v62, v62, v63
    v_add_f32 v66, v66, v67
    v_mfma_f32_16x16x32_bf16 v[228:231], v[44:47], a[228:231], v[228:231]
    v_cvt_pk_bf16_f32 v48, v52, v54
    v_cvt_pk_bf16_f32 v49, v56, v58
    v_mfma_f32_16x16x32_bf16 v[232:235], v[44:47], a[224:227], v[232:235]
    v_cvt_pk_bf16_f32 v50, v60, v62
    v_cvt_pk_bf16_f32 v51, v64, v66
    v_mfma_f32_16x16x32_bf16 v[236:239], v[44:47], a[220:223], v[236:239]
    v_mfma_f32_16x16x32_bf16 v[240:243], v[44:47], a[216:219], v[240:243]
    v_mfma_f32_16x16x32_bf16 v[244:247], v[44:47], a[212:215], v[244:247]
    v_mfma_f32_16x16x32_bf16 v[248:251], v[44:47], a[208:211], v[248:251]
    v_mfma_f32_16x16x32_bf16 v[252:255], v[44:47], a[204:207], v[252:255]
    s_waitcnt lgkmcnt(3)
    v_mfma_f32_16x16x32_bf16 v[148:151], v[32:35], a[12:15], v[148:151]
    s_mov_b32 m0, s61
    s_add_u32 s54, s54, s55
    buffer_load_dwordx4 v16, s[20:23], s54 offen lds
    v_mfma_f32_16x16x32_bf16 v[152:155], v[32:35], a[24:27], v[152:155]
    s_mov_b32 m0, s62
    s_add_u32 s54, s54, s55
    buffer_load_dwordx4 v16, s[20:23], s54 offen lds
    v_mfma_f32_16x16x32_bf16 v[156:159], v[32:35], a[80:83], v[156:159]
    s_waitcnt lgkmcnt(1)
    v_mfma_f32_16x16x32_bf16 v[72:75], v[24:27], v[80:83], 0
    s_waitcnt vmcnt(5)
    ds_read_b64_tr_b16 v[28:29], v18 offset:0
    v_lshlrev_b32 v52, 16, v92
    v_mfma_f32_16x16x32_bf16 v[160:163], v[32:35], a[68:71], v[160:163]
    ds_read_b64_tr_b16 v[30:31], v18 offset:256
    v_lshlrev_b32 v56, 16, v93
    v_mfma_f32_16x16x32_bf16 v[164:167], v[32:35], a[56:59], v[164:167]
    ds_read_b64_tr_b16 v[36:37], v18 offset:1024
    v_lshlrev_b32 v60, 16, v94
    v_mfma_f32_16x16x32_bf16 v[168:171], v[32:35], a[52:55], v[168:171]
    ds_read_b64_tr_b16 v[38:39], v18 offset:1280
    v_lshlrev_b32 v64, 16, v95
    v_mfma_f32_16x16x32_bf16 v[172:175], v[32:35], a[48:51], v[172:175]
    ds_read_b128 a[4:7], v10 offset:1152
    v_lshlrev_b32 v53, 16, v96
    v_mfma_f32_16x16x32_bf16 v[176:179], v[32:35], a[44:47], v[176:179]
    ds_read_b128 a[160:163], v11 offset:1152
    v_lshlrev_b32 v57, 16, v97
    v_mfma_f32_16x16x32_bf16 v[180:183], v[32:35], a[40:43], v[180:183]
    ds_read_b128 a[244:247], v12 offset:1152
    v_lshlrev_b32 v61, 16, v98
    v_mfma_f32_16x16x32_bf16 v[184:187], v[40:43], a[156:159], v[184:187]
    ds_read_b128 a[164:167], v11 offset:4384
    v_lshlrev_b32 v65, 16, v99
    v_mfma_f32_16x16x32_bf16 v[188:191], v[40:43], a[152:155], v[188:191]
    ds_read_b128 a[116:119], v11 offset:4672
    s_mov_b32 s51, 36864
    v_and_b32 v54, s47, v92
    v_mfma_f32_16x16x32_bf16 v[192:195], v[40:43], a[148:151], v[192:195]
    buffer_store_dwordx4 v[104:107], v100, s[32:35], s51 offen sc1
    v_mfma_f32_16x16x32_bf16 v[196:199], v[40:43], a[144:147], v[196:199]
    ds_read_b128 v[76:79], v19 offset:36928
    v_and_b32 v58, s47, v93
    v_mfma_f32_16x16x32_bf16 v[200:203], v[40:43], a[140:143], v[200:203]
    v_cvt_pk_bf16_f32 v86, v72, v73
    v_cvt_pk_bf16_f32 v87, v74, v75
    v_mfma_f32_16x16x32_bf16 v[204:207], v[40:43], a[136:139], v[204:207]
    ds_write_b64 v20, v[86:87] offset:32320
    v_and_b32 v62, s47, v94
    v_mfma_f32_16x16x32_bf16 v[208:211], v[40:43], a[132:135], v[208:211]
    v_and_b32 v66, s47, v95
    v_and_b32 v55, s47, v96
    v_mfma_f32_16x16x32_bf16 v[212:215], v[40:43], a[128:131], v[212:215]
    v_and_b32 v59, s47, v97
    v_and_b32 v63, s47, v98
    v_mfma_f32_16x16x32_bf16 v[216:219], v[40:43], a[124:127], v[216:219]
    v_and_b32 v67, s47, v99
    v_add_f32 v52, v52, v53
    v_mfma_f32_16x16x32_bf16 v[220:223], v[48:51], a[240:243], v[220:223]
    v_add_f32 v56, v56, v57
    v_add_f32 v60, v60, v61
    v_mfma_f32_16x16x32_bf16 v[224:227], v[48:51], a[236:239], v[224:227]
    v_add_f32 v64, v64, v65
    v_add_f32 v54, v54, v55
    v_mfma_f32_16x16x32_bf16 v[228:231], v[48:51], a[232:235], v[228:231]
    v_add_f32 v58, v58, v59
    v_add_f32 v62, v62, v63
    v_mfma_f32_16x16x32_bf16 v[232:235], v[48:51], a[228:231], v[232:235]
    v_add_f32 v66, v66, v67
    v_cvt_pk_bf16_f32 v144, v52, v54
    v_mfma_f32_16x16x32_bf16 v[236:239], v[48:51], a[224:227], v[236:239]
    v_cvt_pk_bf16_f32 v145, v56, v58
    v_cvt_pk_bf16_f32 v146, v60, v62
    v_mfma_f32_16x16x32_bf16 v[240:243], v[48:51], a[220:223], v[240:243]
    v_cvt_pk_bf16_f32 v147, v64, v66
    v_mfma_f32_16x16x32_bf16 v[244:247], v[48:51], a[216:219], v[244:247]
    v_mfma_f32_16x16x32_bf16 v[248:251], v[48:51], a[212:215], v[248:251]
    v_mfma_f32_16x16x32_bf16 v[252:255], v[48:51], a[208:211], v[252:255]
    s_waitcnt lgkmcnt(4)
    v_mfma_f32_16x16x32_bf16 v[148:151], v[92:95], a[4:7], v[148:151]
    s_mov_b32 m0, s57
    s_add_u32 s54, s54, s55
    buffer_load_dwordx4 v16, s[20:23], s54 offen lds
    v_mfma_f32_16x16x32_bf16 v[152:155], v[92:95], a[12:15], v[152:155]
    s_waitcnt lgkmcnt(1)
    v_mfma_f32_16x16x32_bf16 v[68:71], v[24:27], v[76:79], 0
    s_waitcnt vmcnt(4)
    ds_read_b64_tr_b16 v[32:33], v18 offset:2048
    v_lshlrev_b32 v52, 16, v28
    v_mfma_f32_16x16x32_bf16 v[156:159], v[92:95], a[24:27], v[156:159]
    ds_read_b64_tr_b16 v[34:35], v18 offset:2304
    v_lshlrev_b32 v56, 16, v29
    v_mfma_f32_16x16x32_bf16 v[160:163], v[92:95], a[80:83], v[160:163]
    ds_read_b64_tr_b16 v[40:41], v18 offset:3072
    v_lshlrev_b32 v60, 16, v30
    v_mfma_f32_16x16x32_bf16 v[164:167], v[92:95], a[68:71], v[164:167]
    ds_read_b64_tr_b16 v[42:43], v18 offset:3328
    v_lshlrev_b32 v64, 16, v31
    v_mfma_f32_16x16x32_bf16 v[168:171], v[92:95], a[56:59], v[168:171]
    ds_read_b128 a[0:3], v10 offset:864
    v_lshlrev_b32 v53, 16, v36
    v_mfma_f32_16x16x32_bf16 v[172:175], v[92:95], a[52:55], v[172:175]
    ds_read_b128 a[112:115], v11 offset:864
    v_lshlrev_b32 v57, 16, v37
    v_mfma_f32_16x16x32_bf16 v[176:179], v[92:95], a[48:51], v[176:179]
    ds_read_b128 a[248:251], v12 offset:864
    v_lshlrev_b32 v61, 16, v38
    v_mfma_f32_16x16x32_bf16 v[180:183], v[92:95], a[44:47], v[180:183]
    ds_read_b128 a[108:111], v11 offset:4960
    v_lshlrev_b32 v65, 16, v39
    v_mfma_f32_16x16x32_bf16 v[184:187], v[96:99], a[160:163], v[184:187]
    ds_read_b128 a[104:107], v11 offset:5248
    v_and_b32 v54, s47, v28
    v_mfma_f32_16x16x32_bf16 v[188:191], v[96:99], a[156:159], v[188:191]
    ds_read_b128 v[80:83], v19 offset:41248
    v_and_b32 v58, s47, v29
    v_mfma_f32_16x16x32_bf16 v[192:195], v[96:99], a[152:155], v[192:195]
    v_cvt_pk_bf16_f32 v84, v68, v69
    v_cvt_pk_bf16_f32 v85, v70, v71
    v_mfma_f32_16x16x32_bf16 v[196:199], v[96:99], a[148:151], v[196:199]
    ds_write_b64 v20, v[84:85] offset:36928
    v_and_b32 v62, s47, v30
    v_mfma_f32_16x16x32_bf16 v[200:203], v[96:99], a[144:147], v[200:203]
    v_and_b32 v66, s47, v31
    v_and_b32 v55, s47, v36
    v_mfma_f32_16x16x32_bf16 v[204:207], v[96:99], a[140:143], v[204:207]
    v_and_b32 v59, s47, v37
    v_and_b32 v63, s47, v38
    v_mfma_f32_16x16x32_bf16 v[208:211], v[96:99], a[136:139], v[208:211]
    v_and_b32 v67, s47, v39
    v_add_f32 v52, v52, v53
    v_mfma_f32_16x16x32_bf16 v[212:215], v[96:99], a[132:135], v[212:215]
    v_add_f32 v56, v56, v57
    v_add_f32 v60, v60, v61
    v_mfma_f32_16x16x32_bf16 v[216:219], v[96:99], a[128:131], v[216:219]
    v_add_f32 v64, v64, v65
    v_add_f32 v54, v54, v55
    v_mfma_f32_16x16x32_bf16 v[220:223], v[144:147], a[244:247], v[220:223]
    v_add_f32 v58, v58, v59
    v_add_f32 v62, v62, v63
    v_mfma_f32_16x16x32_bf16 v[224:227], v[144:147], a[240:243], v[224:227]
    v_add_f32 v66, v66, v67
    v_cvt_pk_bf16_f32 v44, v52, v54
    v_mfma_f32_16x16x32_bf16 v[228:231], v[144:147], a[236:239], v[228:231]
    v_cvt_pk_bf16_f32 v45, v56, v58
    v_cvt_pk_bf16_f32 v46, v60, v62
    v_mfma_f32_16x16x32_bf16 v[232:235], v[144:147], a[232:235], v[232:235]
    v_cvt_pk_bf16_f32 v47, v64, v66
    v_mfma_f32_16x16x32_bf16 v[236:239], v[144:147], a[228:231], v[236:239]
    v_mfma_f32_16x16x32_bf16 v[240:243], v[144:147], a[224:227], v[240:243]
    v_mfma_f32_16x16x32_bf16 v[244:247], v[144:147], a[220:223], v[244:247]
    v_mfma_f32_16x16x32_bf16 v[248:251], v[144:147], a[216:219], v[248:251]
    v_mfma_f32_16x16x32_bf16 v[252:255], v[144:147], a[212:215], v[252:255]
    s_waitcnt lgkmcnt(4)
    v_mfma_f32_16x16x32_bf16 v[148:151], v[28:31], a[0:3], v[148:151]
    s_mov_b32 m0, s58
    s_mov_b32 s54, 18432
    buffer_load_dwordx4 v16, s[20:23], s54 offen lds
    v_mfma_f32_16x16x32_bf16 v[152:155], v[28:31], a[4:7], v[152:155]
    s_mov_b32 m0, s59
    s_add_u32 s54, s54, s55
    buffer_load_dwordx4 v16, s[20:23], s54 offen lds
    v_mfma_f32_16x16x32_bf16 v[156:159], v[28:31], a[12:15], v[156:159]
    s_waitcnt lgkmcnt(1)
    v_mfma_f32_16x16x32_bf16 v[72:75], v[24:27], v[80:83], 0
    s_waitcnt vmcnt(4)
    ds_read_b64_tr_b16 v[92:93], v18 offset:4096
    v_lshlrev_b32 v52, 16, v32
    v_mfma_f32_16x16x32_bf16 v[160:163], v[28:31], a[24:27], v[160:163]
    ds_read_b64_tr_b16 v[94:95], v18 offset:4352
    v_lshlrev_b32 v56, 16, v33
    v_mfma_f32_16x16x32_bf16 v[164:167], v[28:31], a[80:83], v[164:167]
    ds_read_b64_tr_b16 v[96:97], v18 offset:5120
    v_lshlrev_b32 v60, 16, v34
    v_mfma_f32_16x16x32_bf16 v[168:171], v[28:31], a[68:71], v[168:171]
    ds_read_b64_tr_b16 v[98:99], v18 offset:5376
    v_lshlrev_b32 v64, 16, v35
    v_mfma_f32_16x16x32_bf16 v[172:175], v[28:31], a[56:59], v[172:175]
    ds_read_b128 a[36:39], v10 offset:576
    v_lshlrev_b32 v53, 16, v40
    v_mfma_f32_16x16x32_bf16 v[176:179], v[28:31], a[52:55], v[176:179]
    ds_read_b128 a[100:103], v11 offset:576
    v_lshlrev_b32 v57, 16, v41
    v_mfma_f32_16x16x32_bf16 v[180:183], v[28:31], a[48:51], v[180:183]
    ds_read_b128 a[200:203], v12 offset:576
    v_lshlrev_b32 v61, 16, v42
    v_mfma_f32_16x16x32_bf16 v[184:187], v[36:39], a[112:115], v[184:187]
    ds_read_b128 a[96:99], v11 offset:5536
    v_lshlrev_b32 v65, 16, v43
    v_mfma_f32_16x16x32_bf16 v[188:191], v[36:39], a[160:163], v[188:191]
    ds_read_b128 a[92:95], v11 offset:5824
    s_mov_b32 s100, 681984
    v_and_b32 v54, s47, v32
    v_mfma_f32_16x16x32_bf16 v[192:195], v[36:39], a[156:159], v[192:195]
    buffer_load_dword v21, v0, s[20:23], s100 offen
    v_mfma_f32_16x16x32_bf16 v[196:199], v[36:39], a[152:155], v[196:199]
    v_and_b32 v58, s47, v33
    v_cvt_pk_bf16_f32 v86, v72, v73
    v_mfma_f32_16x16x32_bf16 v[200:203], v[36:39], a[148:151], v[200:203]
    v_cvt_pk_bf16_f32 v87, v74, v75
    ds_write_b64 v20, v[86:87] offset:41248
    v_mfma_f32_16x16x32_bf16 v[204:207], v[36:39], a[144:147], v[204:207]
    v_and_b32 v62, s47, v34
    v_and_b32 v66, s47, v35
    v_mfma_f32_16x16x32_bf16 v[208:211], v[36:39], a[140:143], v[208:211]
    v_and_b32 v55, s47, v40
    v_and_b32 v59, s47, v41
    v_mfma_f32_16x16x32_bf16 v[212:215], v[36:39], a[136:139], v[212:215]
    v_and_b32 v63, s47, v42
    v_and_b32 v67, s47, v43
    v_mfma_f32_16x16x32_bf16 v[216:219], v[36:39], a[132:135], v[216:219]
    v_add_f32 v52, v52, v53
    v_add_f32 v56, v56, v57
    v_mfma_f32_16x16x32_bf16 v[220:223], v[44:47], a[248:251], v[220:223]
    v_add_f32 v60, v60, v61
    v_add_f32 v64, v64, v65
    v_mfma_f32_16x16x32_bf16 v[224:227], v[44:47], a[244:247], v[224:227]
    v_add_f32 v54, v54, v55
    v_add_f32 v58, v58, v59
    v_mfma_f32_16x16x32_bf16 v[228:231], v[44:47], a[240:243], v[228:231]
    v_add_f32 v62, v62, v63
    v_add_f32 v66, v66, v67
    v_mfma_f32_16x16x32_bf16 v[232:235], v[44:47], a[236:239], v[232:235]
    v_cvt_pk_bf16_f32 v48, v52, v54
    v_cvt_pk_bf16_f32 v49, v56, v58
    v_mfma_f32_16x16x32_bf16 v[236:239], v[44:47], a[232:235], v[236:239]
    v_cvt_pk_bf16_f32 v50, v60, v62
    v_cvt_pk_bf16_f32 v51, v64, v66
    v_mfma_f32_16x16x32_bf16 v[240:243], v[44:47], a[228:231], v[240:243]
    v_mfma_f32_16x16x32_bf16 v[244:247], v[44:47], a[224:227], v[244:247]
    v_mfma_f32_16x16x32_bf16 v[248:251], v[44:47], a[220:223], v[248:251]
    v_mfma_f32_16x16x32_bf16 v[252:255], v[44:47], a[216:219], v[252:255]
    s_waitcnt lgkmcnt(3)
    v_mfma_f32_16x16x32_bf16 v[148:151], v[32:35], a[36:39], v[148:151]
    s_waitcnt lgkmcnt(0)
    s_barrier
    s_mov_b32 m0, s60
    v_lshlrev_b32 v52, 16, v92
    v_lshlrev_b32 v56, 16, v93
    v_mfma_f32_16x16x32_bf16 v[152:155], v[32:35], a[0:3], v[152:155]
    s_add_u32 s54, s54, s55
    buffer_load_dwordx4 v16, s[20:23], s54 offen lds
    v_mfma_f32_16x16x32_bf16 v[156:159], v[32:35], a[4:7], v[156:159]
    s_mov_b32 m0, s61
    s_add_u32 s54, s54, s55
    buffer_load_dwordx4 v16, s[20:23], s54 offen lds
    v_mfma_f32_16x16x32_bf16 v[160:163], v[32:35], a[12:15], v[160:163]
    s_waitcnt vmcnt(5)
    ds_read_b64_tr_b16 v[28:29], v18 offset:0
    v_lshlrev_b32 v60, 16, v94
    v_mfma_f32_16x16x32_bf16 v[164:167], v[32:35], a[24:27], v[164:167]
    ds_read_b64_tr_b16 v[30:31], v18 offset:256
    v_lshlrev_b32 v64, 16, v95
    v_mfma_f32_16x16x32_bf16 v[168:171], v[32:35], a[80:83], v[168:171]
    ds_read_b128 a[40:43], v10 offset:288
    v_lshlrev_b32 v53, 16, v96
    v_mfma_f32_16x16x32_bf16 v[172:175], v[32:35], a[68:71], v[172:175]
    ds_read_b128 a[88:91], v11 offset:288
    v_lshlrev_b32 v57, 16, v97
    v_mfma_f32_16x16x32_bf16 v[176:179], v[32:35], a[56:59], v[176:179]
    ds_read_b128 a[196:199], v12 offset:288
    v_lshlrev_b32 v61, 16, v98
    v_mfma_f32_16x16x32_bf16 v[180:183], v[32:35], a[52:55], v[180:183]
    ds_read_b128 a[84:87], v11 offset:6112
    v_lshlrev_b32 v65, 16, v99
    v_mfma_f32_16x16x32_bf16 v[184:187], v[40:43], a[100:103], v[184:187]
    ds_read_b128 a[120:123], v11 offset:6400
    v_and_b32 v54, s47, v92
    v_mfma_f32_16x16x32_bf16 v[188:191], v[40:43], a[112:115], v[188:191]
    ds_read_b128 a[192:195], v12 offset:4384
    v_and_b32 v58, s47, v93
    v_mfma_f32_16x16x32_bf16 v[192:195], v[40:43], a[160:163], v[192:195]
    ds_read_b128 a[188:191], v12 offset:4672
    v_and_b32 v62, s47, v94
    v_mfma_f32_16x16x32_bf16 v[196:199], v[40:43], a[156:159], v[196:199]
    ds_read_b128 a[184:187], v12 offset:4960
    v_and_b32 v66, s47, v95
    v_mfma_f32_16x16x32_bf16 v[200:203], v[40:43], a[152:155], v[200:203]
    v_and_b32 v55, s47, v96
    v_and_b32 v59, s47, v97
    v_mfma_f32_16x16x32_bf16 v[204:207], v[40:43], a[148:151], v[204:207]
    v_and_b32 v63, s47, v98
    v_and_b32 v67, s47, v99
    v_mfma_f32_16x16x32_bf16 v[208:211], v[40:43], a[144:147], v[208:211]
    v_add_f32 v52, v52, v53
    v_add_f32 v56, v56, v57
    v_mfma_f32_16x16x32_bf16 v[212:215], v[40:43], a[140:143], v[212:215]
    v_add_f32 v60, v60, v61
    v_add_f32 v64, v64, v65
    v_mfma_f32_16x16x32_bf16 v[216:219], v[40:43], a[136:139], v[216:219]
    v_add_f32 v54, v54, v55
    v_add_f32 v58, v58, v59
    v_mfma_f32_16x16x32_bf16 v[220:223], v[48:51], a[200:203], v[220:223]
    v_add_f32 v62, v62, v63
    v_add_f32 v66, v66, v67
    v_mfma_f32_16x16x32_bf16 v[224:227], v[48:51], a[248:251], v[224:227]
    v_cvt_pk_bf16_f32 v144, v52, v54
    v_cvt_pk_bf16_f32 v145, v56, v58
    v_mfma_f32_16x16x32_bf16 v[228:231], v[48:51], a[244:247], v[228:231]
    v_cvt_pk_bf16_f32 v146, v60, v62
    v_cvt_pk_bf16_f32 v147, v64, v66
    v_mfma_f32_16x16x32_bf16 v[232:235], v[48:51], a[240:243], v[232:235]
    v_mfma_f32_16x16x32_bf16 v[236:239], v[48:51], a[236:239], v[236:239]
    v_mfma_f32_16x16x32_bf16 v[240:243], v[48:51], a[232:235], v[240:243]
    v_mfma_f32_16x16x32_bf16 v[244:247], v[48:51], a[228:231], v[244:247]
    v_mfma_f32_16x16x32_bf16 v[248:251], v[48:51], a[224:227], v[248:251]
    v_mfma_f32_16x16x32_bf16 v[252:255], v[48:51], a[220:223], v[252:255]
    s_waitcnt lgkmcnt(5)
    v_mfma_f32_16x16x32_bf16 v[148:151], v[92:95], a[40:43], v[148:151]
    s_mov_b32 m0, s62
    s_add_u32 s54, s54, s55
    buffer_load_dwordx4 v16, s[20:23], s54 offen lds
    v_mfma_f32_16x16x32_bf16 v[152:155], v[92:95], a[36:39], v[152:155]
    s_mov_b32 m0, s57
    s_add_u32 s54, s54, s55
    buffer_load_dwordx4 v16, s[20:23], s54 offen lds
    v_mfma_f32_16x16x32_bf16 v[156:159], v[92:95], a[0:3], v[156:159]
    s_waitcnt vmcnt(5)
    ds_read_b64_tr_b16 v[32:33], v18 offset:1024
    s_mov_b32 s4, 1664525
    v_mul_lo_u32 v8, v9, s4
    v_mfma_f32_16x16x32_bf16 v[160:163], v[92:95], a[4:7], v[160:163]
    ds_read_b64_tr_b16 v[34:35], v18 offset:1280
    v_add_u32 v8, 1013904223, v8
    v_mfma_f32_16x16x32_bf16 v[164:167], v[92:95], a[12:15], v[164:167]
    ds_read_b64_tr_b16 v[40:41], v18 offset:2048
    v_mfma_f32_16x16x32_bf16 v[168:171], v[92:95], a[24:27], v[168:171]
    ds_read_b64_tr_b16 v[42:43], v18 offset:2304
    v_mfma_f32_16x16x32_bf16 v[172:175], v[92:95], a[80:83], v[172:175]
    ds_read_b128 a[44:47], v10 offset:0
    v_mfma_f32_16x16x32_bf16 v[176:179], v[92:95], a[68:71], v[176:179]
    ds_read_b128 a[180:183], v12 offset:0
    v_mfma_f32_16x16x32_bf16 v[180:183], v[92:95], a[56:59], v[180:183]
    ds_read_b128 a[124:127], v11 offset:6688
    v_mfma_f32_16x16x32_bf16 v[184:187], v[96:99], a[88:91], v[184:187]
    ds_read_b128 a[176:179], v12 offset:5248
    v_mfma_f32_16x16x32_bf16 v[188:191], v[96:99], a[100:103], v[188:191]
    ds_read_b128 a[172:175], v12 offset:5536
    v_mfma_f32_16x16x32_bf16 v[192:195], v[96:99], a[112:115], v[192:195]
    ds_read_b128 a[168:171], v12 offset:5824
    s_mov_b32 s51, 73728
    v_mfma_f32_16x16x32_bf16 v[196:199], v[96:99], a[160:163], v[196:199]
    buffer_store_dwordx4 v[104:107], v100, s[32:35], s51 offen sc1
    v_mfma_f32_16x16x32_bf16 v[200:203], v[96:99], a[156:159], v[200:203]
    v_mfma_f32_16x16x32_bf16 v[204:207], v[96:99], a[152:155], v[204:207]
    v_mfma_f32_16x16x32_bf16 v[208:211], v[96:99], a[148:151], v[208:211]
    v_mfma_f32_16x16x32_bf16 v[212:215], v[96:99], a[144:147], v[212:215]
    v_mfma_f32_16x16x32_bf16 v[216:219], v[96:99], a[140:143], v[216:219]
    v_mfma_f32_16x16x32_bf16 v[220:223], v[144:147], a[196:199], v[220:223]
    v_mfma_f32_16x16x32_bf16 v[224:227], v[144:147], a[200:203], v[224:227]
    v_mfma_f32_16x16x32_bf16 v[228:231], v[144:147], a[248:251], v[228:231]
    v_mfma_f32_16x16x32_bf16 v[232:235], v[144:147], a[244:247], v[232:235]
    v_mfma_f32_16x16x32_bf16 v[236:239], v[144:147], a[240:243], v[236:239]
    v_mfma_f32_16x16x32_bf16 v[240:243], v[144:147], a[236:239], v[240:243]
    v_mfma_f32_16x16x32_bf16 v[244:247], v[144:147], a[232:235], v[244:247]
    v_mfma_f32_16x16x32_bf16 v[248:251], v[144:147], a[228:231], v[248:251]
    v_mfma_f32_16x16x32_bf16 v[252:255], v[144:147], a[224:227], v[252:255]
    s_waitcnt lgkmcnt(4)
    v_mfma_f32_16x16x32_bf16 v[148:151], v[28:31], a[44:47], v[148:151]
    s_mov_b32 m0, s58
    s_add_u32 s54, s54, s55
    buffer_load_dwordx4 v16, s[20:23], s54 offen lds
    v_mfma_f32_16x16x32_bf16 v[152:155], v[28:31], a[40:43], v[152:155]
    s_mov_b32 m0, s59
    s_add_u32 s54, s54, s55
    buffer_load_dwordx4 v16, s[20:23], s54 offen lds
    v_mfma_f32_16x16x32_bf16 v[156:159], v[28:31], a[36:39], v[156:159]
    s_waitcnt vmcnt(5)
    ds_read_b64_tr_b16 v[92:93], v18 offset:3072
    v_lshlrev_b32 v52, 16, v32
    v_mfma_f32_16x16x32_bf16 v[160:163], v[28:31], a[0:3], v[160:163]
    ds_read_b64_tr_b16 v[94:95], v18 offset:3328
    v_lshlrev_b32 v56, 16, v33
    v_mfma_f32_16x16x32_bf16 v[164:167], v[28:31], a[4:7], v[164:167]
    ds_read_b64_tr_b16 v[96:97], v18 offset:4096
    v_lshlrev_b32 v60, 16, v34
    v_mfma_f32_16x16x32_bf16 v[168:171], v[28:31], a[12:15], v[168:171]
    ds_read_b64_tr_b16 v[98:99], v18 offset:4352
    v_lshlrev_b32 v64, 16, v35
    v_mfma_f32_16x16x32_bf16 v[172:175], v[28:31], a[24:27], v[172:175]
    ds_read_b128 a[204:207], v12 offset:6112
    v_lshlrev_b32 v53, 16, v40
    v_mfma_f32_16x16x32_bf16 v[176:179], v[28:31], a[80:83], v[176:179]
    ds_read_b128 a[208:211], v12 offset:6400
    v_lshlrev_b32 v57, 16, v41
    v_mfma_f32_16x16x32_bf16 v[180:183], v[28:31], a[68:71], v[180:183]
    ds_read_b128 a[212:215], v12 offset:6688
    v_lshlrev_b32 v61, 16, v42
    v_mfma_f32_16x16x32_bf16 v[220:223], v[28:31], a[180:183], v[220:223]
    v_lshlrev_b32 v65, 16, v43
    v_and_b32 v54, s47, v32
    v_mfma_f32_16x16x32_bf16 v[224:227], v[28:31], a[196:199], v[224:227]
    v_and_b32 v58, s47, v33
    v_and_b32 v62, s47, v34
    v_mfma_f32_16x16x32_bf16 v[228:231], v[28:31], a[200:203], v[228:231]
    v_and_b32 v66, s47, v35
    v_and_b32 v55, s47, v40
    v_mfma_f32_16x16x32_bf16 v[232:235], v[28:31], a[248:251], v[232:235]
    v_and_b32 v59, s47, v41
    v_and_b32 v63, s47, v42
    v_mfma_f32_16x16x32_bf16 v[236:239], v[28:31], a[244:247], v[236:239]
    v_and_b32 v67, s47, v43
    v_add_f32 v52, v52, v53
    v_mfma_f32_16x16x32_bf16 v[240:243], v[28:31], a[240:243], v[240:243]
    v_add_f32 v56, v56, v57
    v_add_f32 v60, v60, v61
    v_mfma_f32_16x16x32_bf16 v[244:247], v[28:31], a[236:239], v[244:247]
    v_add_f32 v64, v64, v65
    v_add_f32 v54, v54, v55
    v_mfma_f32_16x16x32_bf16 v[248:251], v[28:31], a[232:235], v[248:251]
    v_add_f32 v58, v58, v59
    v_add_f32 v62, v62, v63
    v_mfma_f32_16x16x32_bf16 v[252:255], v[28:31], a[228:231], v[252:255]
    v_add_f32 v66, v66, v67
    v_cvt_pk_bf16_f32 v48, v52, v54
    v_cvt_pk_bf16_f32 v49, v56, v58
    v_cvt_pk_bf16_f32 v50, v60, v62
    v_cvt_pk_bf16_f32 v51, v64, v66
    s_waitcnt lgkmcnt(0)
    v_mfma_f32_16x16x32_bf16 v[148:151], v[32:35], a[60:63], v[148:151]
    s_mov_b32 m0, s60
    s_add_u32 s54, s54, s55
    buffer_load_dwordx4 v16, s[20:23], s54 offen lds
    v_mfma_f32_16x16x32_bf16 v[152:155], v[32:35], a[64:67], v[152:155]
    s_mov_b32 m0, s61
    s_add_u32 s54, s54, s55
    buffer_load_dwordx4 v16, s[20:23], s54 offen lds
    v_mfma_f32_16x16x32_bf16 v[156:159], v[32:35], a[72:75], v[156:159]
    s_waitcnt vmcnt(5)
    ds_read_b64_tr_b16 v[28:29], v18 offset:5120
    v_lshlrev_b32 v52, 16, v92
    v_mfma_f32_16x16x32_bf16 v[160:163], v[32:35], a[76:79], v[160:163]
    ds_read_b64_tr_b16 v[30:31], v18 offset:5376
    v_lshlrev_b32 v56, 16, v93
    v_mfma_f32_16x16x32_bf16 v[164:167], v[32:35], a[32:35], v[164:167]
    ds_read_b64_tr_b16 v[36:37], v18 offset:0
    v_lshlrev_b32 v60, 16, v94
    v_mfma_f32_16x16x32_bf16 v[168:171], v[32:35], a[28:31], v[168:171]
    ds_read_b64_tr_b16 v[38:39], v18 offset:256
    v_lshlrev_b32 v64, 16, v95
    v_mfma_f32_16x16x32_bf16 v[172:175], v[32:35], a[20:23], v[172:175]
    ds_read_b128 a[48:51], v10 offset:4096
    v_lshlrev_b32 v53, 16, v96
    v_mfma_f32_16x16x32_bf16 v[176:179], v[32:35], a[16:19], v[176:179]
    ds_read_b128 a[128:131], v11 offset:4096
    v_lshlrev_b32 v57, 16, v97
    v_mfma_f32_16x16x32_bf16 v[180:183], v[32:35], a[8:11], v[180:183]
    ds_read_b128 a[216:219], v12 offset:4096
    s_mov_b32 s100, 1345536
    v_lshlrev_b32 v61, 16, v98
    v_mfma_f32_16x16x32_bf16 v[184:187], v[40:43], a[164:167], v[184:187]
    buffer_load_dword v21, v0, s[20:23], s100 offen
    v_mfma_f32_16x16x32_bf16 v[188:191], v[40:43], a[116:119], v[188:191]
    v_lshlrev_b32 v65, 16, v99
    v_and_b32 v54, s47, v92
    v_mfma_f32_16x16x32_bf16 v[192:195], v[40:43], a[108:111], v[192:195]
    v_and_b32 v58, s47, v93
    v_and_b32 v62, s47, v94
    v_mfma_f32_16x16x32_bf16 v[196:199], v[40:43], a[104:107], v[196:199]
    v_and_b32 v66, s47, v95
    v_and_b32 v55, s47, v96
    v_mfma_f32_16x16x32_bf16 v[200:203], v[40:43], a[96:99], v[200:203]
    v_and_b32 v59, s47, v97
    v_and_b32 v63, s47, v98
    v_mfma_f32_16x16x32_bf16 v[204:207], v[40:43], a[92:95], v[204:207]
    v_and_b32 v67, s47, v99
    v_add_f32 v52, v52, v53
    v_mfma_f32_16x16x32_bf16 v[208:211], v[40:43], a[84:87], v[208:211]
    v_add_f32 v56, v56, v57
    v_add_f32 v60, v60, v61
    v_mfma_f32_16x16x32_bf16 v[212:215], v[40:43], a[120:123], v[212:215]
    v_add_f32 v64, v64, v65
    v_add_f32 v54, v54, v55
    v_mfma_f32_16x16x32_bf16 v[216:219], v[40:43], a[124:127], v[216:219]
    v_add_f32 v58, v58, v59
    v_add_f32 v62, v62, v63
    v_mfma_f32_16x16x32_bf16 v[220:223], v[48:51], a[192:195], v[220:223]
    v_add_f32 v66, v66, v67
    v_cvt_pk_bf16_f32 v144, v52, v54
    v_mfma_f32_16x16x32_bf16 v[224:227], v[48:51], a[188:191], v[224:227]
    v_cvt_pk_bf16_f32 v145, v56, v58
    v_cvt_pk_bf16_f32 v146, v60, v62
    v_mfma_f32_16x16x32_bf16 v[228:231], v[48:51], a[184:187], v[228:231]
    v_cvt_pk_bf16_f32 v147, v64, v66
    v_mfma_f32_16x16x32_bf16 v[232:235], v[48:51], a[176:179], v[232:235]
    v_mfma_f32_16x16x32_bf16 v[236:239], v[48:51], a[172:175], v[236:239]
    v_mfma_f32_16x16x32_bf16 v[240:243], v[48:51], a[168:171], v[240:243]
    v_mfma_f32_16x16x32_bf16 v[244:247], v[48:51], a[204:207], v[244:247]
    v_mfma_f32_16x16x32_bf16 v[248:251], v[48:51], a[208:211], v[248:251]
    v_mfma_f32_16x16x32_bf16 v[252:255], v[48:51], a[212:215], v[252:255]
    s_waitcnt lgkmcnt(0)
    v_mfma_f32_16x16x32_bf16 v[148:151], v[92:95], a[48:51], v[148:151]
    s_mov_b32 m0, s62
    s_add_u32 s54, s54, s55
    buffer_load_dwordx4 v16, s[20:23], s54 offen lds
    v_mfma_f32_16x16x32_bf16 v[152:155], v[92:95], a[60:63], v[152:155]
    s_mov_b32 m0, s57
    s_add_u32 s54, s54, s55
    buffer_load_dwordx4 v16, s[20:23], s54 offen lds
    v_mfma_f32_16x16x32_bf16 v[156:159], v[92:95], a[64:67], v[156:159]
    s_waitcnt vmcnt(5)
    ds_read_b64_tr_b16 v[32:33], v18 offset:1024
    v_lshlrev_b32 v52, 16, v28
    v_mfma_f32_16x16x32_bf16 v[160:163], v[92:95], a[72:75], v[160:163]
    ds_read_b64_tr_b16 v[34:35], v18 offset:1280
    v_lshlrev_b32 v56, 16, v29
    v_mfma_f32_16x16x32_bf16 v[164:167], v[92:95], a[76:79], v[164:167]
    ds_read_b64_tr_b16 v[40:41], v18 offset:2048
    v_lshlrev_b32 v60, 16, v30
    v_mfma_f32_16x16x32_bf16 v[168:171], v[92:95], a[32:35], v[168:171]
    ds_read_b64_tr_b16 v[42:43], v18 offset:2304
    v_lshlrev_b32 v64, 16, v31
    v_mfma_f32_16x16x32_bf16 v[172:175], v[92:95], a[28:31], v[172:175]
    ds_read_b128 a[52:55], v10 offset:3808
    v_lshlrev_b32 v53, 16, v36
    v_mfma_f32_16x16x32_bf16 v[176:179], v[92:95], a[20:23], v[176:179]
    ds_read_b128 a[132:135], v11 offset:3808
    v_lshlrev_b32 v57, 16, v37
    v_mfma_f32_16x16x32_bf16 v[180:183], v[92:95], a[16:19], v[180:183]
    ds_read_b128 a[220:223], v12 offset:3808
    v_lshlrev_b32 v61, 16, v38
    v_mfma_f32_16x16x32_bf16 v[184:187], v[96:99], a[128:131], v[184:187]
    v_lshlrev_b32 v65, 16, v39
    v_and_b32 v54, s47, v28
    v_mfma_f32_16x16x32_bf16 v[188:191], v[96:99], a[164:167], v[188:191]
    v_and_b32 v58, s47, v29
    v_and_b32 v62, s47, v30
    v_mfma_f32_16x16x32_bf16 v[192:195], v[96:99], a[116:119], v[192:195]
    v_and_b32 v66, s47, v31
    v_and_b32 v55, s47, v36
    v_mfma_f32_16x16x32_bf16 v[196:199], v[96:99], a[108:111], v[196:199]
    v_and_b32 v59, s47, v37
    v_and_b32 v63, s47, v38
    v_mfma_f32_16x16x32_bf16 v[200:203], v[96:99], a[104:107], v[200:203]
    v_and_b32 v67, s47, v39
    v_add_f32 v52, v52, v53
    v_mfma_f32_16x16x32_bf16 v[204:207], v[96:99], a[96:99], v[204:207]
    v_add_f32 v56, v56, v57
    v_add_f32 v60, v60, v61
    v_mfma_f32_16x16x32_bf16 v[208:211], v[96:99], a[92:95], v[208:211]
    v_add_f32 v64, v64, v65
    v_add_f32 v54, v54, v55
    v_mfma_f32_16x16x32_bf16 v[212:215], v[96:99], a[84:87], v[212:215]
    v_add_f32 v58, v58, v59
    v_add_f32 v62, v62, v63
    v_mfma_f32_16x16x32_bf16 v[216:219], v[96:99], a[120:123], v[216:219]
    v_add_f32 v66, v66, v67
    v_cvt_pk_bf16_f32 v44, v52, v54
    v_mfma_f32_16x16x32_bf16 v[220:223], v[144:147], a[216:219], v[220:223]
    v_cvt_pk_bf16_f32 v45, v56, v58
    v_cvt_pk_bf16_f32 v46, v60, v62
    v_mfma_f32_16x16x32_bf16 v[224:227], v[144:147], a[192:195], v[224:227]
    v_cvt_pk_bf16_f32 v47, v64, v66
    v_mfma_f32_16x16x32_bf16 v[228:231], v[144:147], a[188:191], v[228:231]
    v_mfma_f32_16x16x32_bf16 v[232:235], v[144:147], a[184:187], v[232:235]
    v_mfma_f32_16x16x32_bf16 v[236:239], v[144:147], a[176:179], v[236:239]
    v_mfma_f32_16x16x32_bf16 v[240:243], v[144:147], a[172:175], v[240:243]
    v_mfma_f32_16x16x32_bf16 v[244:247], v[144:147], a[168:171], v[244:247]
    v_mfma_f32_16x16x32_bf16 v[248:251], v[144:147], a[204:207], v[248:251]
    v_mfma_f32_16x16x32_bf16 v[252:255], v[144:147], a[208:211], v[252:255]
    s_waitcnt lgkmcnt(0)
    v_mfma_f32_16x16x32_bf16 v[148:151], v[28:31], a[52:55], v[148:151]
    s_mov_b32 m0, s58
    s_add_u32 s54, s54, s55
    buffer_load_dwordx4 v16, s[20:23], s54 offen lds
    v_mfma_f32_16x16x32_bf16 v[152:155], v[28:31], a[48:51], v[152:155]
    s_mov_b32 m0, s59
    s_add_u32 s54, s54, s55
    buffer_load_dwordx4 v16, s[20:23], s54 offen lds
    v_mfma_f32_16x16x32_bf16 v[156:159], v[28:31], a[60:63], v[156:159]
    s_waitcnt vmcnt(5)
    ds_read_b64_tr_b16 v[92:93], v18 offset:3072
    v_lshlrev_b32 v52, 16, v32
    v_mfma_f32_16x16x32_bf16 v[160:163], v[28:31], a[64:67], v[160:163]
    ds_read_b64_tr_b16 v[94:95], v18 offset:3328
    v_lshlrev_b32 v56, 16, v33
    v_mfma_f32_16x16x32_bf16 v[164:167], v[28:31], a[72:75], v[164:167]
    ds_read_b64_tr_b16 v[96:97], v18 offset:4096
    v_lshlrev_b32 v60, 16, v34
    v_mfma_f32_16x16x32_bf16 v[168:171], v[28:31], a[76:79], v[168:171]
    ds_read_b64_tr_b16 v[98:99], v18 offset:4352
    v_lshlrev_b32 v64, 16, v35
    v_mfma_f32_16x16x32_bf16 v[172:175], v[28:31], a[32:35], v[172:175]
    ds_read_b128 a[56:59], v10 offset:3520
    v_lshlrev_b32 v53, 16, v40
    v_mfma_f32_16x16x32_bf16 v[176:179], v[28:31], a[28:31], v[176:179]
    ds_read_b128 a[136:139], v11 offset:3520
    v_lshlrev_b32 v57, 16, v41
    v_mfma_f32_16x16x32_bf16 v[180:183], v[28:31], a[20:23], v[180:183]
    ds_read_b128 a[224:227], v12 offset:3520
    s_mov_b32 s51, 110592
    v_lshlrev_b32 v61, 16, v42
    v_mfma_f32_16x16x32_bf16 v[184:187], v[36:39], a[132:135], v[184:187]
    buffer_store_dwordx4 v[104:107], v100, s[32:35], s51 offen sc1
    v_mfma_f32_16x16x32_bf16 v[188:191], v[36:39], a[128:131], v[188:191]
    ds_read_b128 v[76:79], v88 offset:0
    v_lshlrev_b32 v65, 16, v43
    v_mfma_f32_16x16x32_bf16 v[192:195], v[36:39], a[164:167], v[192:195]
    ds_read_b128 v[80:83], v88 offset:18432
    v_and_b32 v54, s47, v32
    v_mfma_f32_16x16x32_bf16 v[196:199], v[36:39], a[116:119], v[196:199]
    v_and_b32 v58, s47, v33
    v_and_b32 v62, s47, v34
    v_mfma_f32_16x16x32_bf16 v[200:203], v[36:39], a[108:111], v[200:203]
    v_and_b32 v66, s47, v35
    v_and_b32 v55, s47, v40
    v_mfma_f32_16x16x32_bf16 v[204:207], v[36:39], a[104:107], v[204:207]
    v_and_b32 v59, s47, v41
    v_and_b32 v63, s47, v42
    v_mfma_f32_16x16x32_bf16 v[208:211], v[36:39], a[96:99], v[208:211]
    v_and_b32 v67, s47, v43
    v_add_f32 v52, v52, v53
    v_mfma_f32_16x16x32_bf16 v[212:215], v[36:39], a[92:95], v[212:215]
    v_add_f32 v56, v56, v57
    v_add_f32 v60, v60, v61
    v_mfma_f32_16x16x32_bf16 v[216:219], v[36:39], a[84:87], v[216:219]
    v_add_f32 v64, v64, v65
    v_add_f32 v54, v54, v55
    v_mfma_f32_16x16x32_bf16 v[220:223], v[44:47], a[220:223], v[220:223]
    v_add_f32 v58, v58, v59
    v_add_f32 v62, v62, v63
    v_mfma_f32_16x16x32_bf16 v[224:227], v[44:47], a[216:219], v[224:227]
    v_add_f32 v66, v66, v67
    v_cvt_pk_bf16_f32 v48, v52, v54
    v_mfma_f32_16x16x32_bf16 v[228:231], v[44:47], a[192:195], v[228:231]
    v_cvt_pk_bf16_f32 v49, v56, v58
    v_cvt_pk_bf16_f32 v50, v60, v62
    v_mfma_f32_16x16x32_bf16 v[232:235], v[44:47], a[188:191], v[232:235]
    v_cvt_pk_bf16_f32 v51, v64, v66
    v_mfma_f32_16x16x32_bf16 v[236:239], v[44:47], a[184:187], v[236:239]
    v_mfma_f32_16x16x32_bf16 v[240:243], v[44:47], a[176:179], v[240:243]
    v_mfma_f32_16x16x32_bf16 v[244:247], v[44:47], a[172:175], v[244:247]
    v_mfma_f32_16x16x32_bf16 v[248:251], v[44:47], a[168:171], v[248:251]
    v_mfma_f32_16x16x32_bf16 v[252:255], v[44:47], a[204:207], v[252:255]
    s_waitcnt lgkmcnt(2)
    v_mfma_f32_16x16x32_bf16 v[148:151], v[32:35], a[56:59], v[148:151]
    s_mov_b32 m0, s60
    s_add_u32 s54, s54, s55
    buffer_load_dwordx4 v16, s[20:23], s54 offen lds
    v_mfma_f32_16x16x32_bf16 v[152:155], v[32:35], a[52:55], v[152:155]
    s_mov_b32 m0, s61
    s_add_u32 s54, s54, s55
    buffer_load_dwordx4 v16, s[20:23], s54 offen lds
    v_mfma_f32_16x16x32_bf16 v[156:159], v[32:35], a[48:51], v[156:159]
    s_waitcnt lgkmcnt(1)
    v_mfma_f32_16x16x32_bf16 v[68:71], v[24:27], v[76:79], 0
    v_lshlrev_b32 v52, 16, v92
    v_lshlrev_b32 v56, 16, v93
    v_mfma_f32_16x16x32_bf16 v[160:163], v[32:35], a[60:63], v[160:163]
    s_waitcnt lgkmcnt(0)
    v_mfma_f32_16x16x32_bf16 v[72:75], v[24:27], v[80:83], 0
    s_waitcnt vmcnt(5)
    ds_read_b64_tr_b16 v[28:29], v18 offset:5120
    v_lshlrev_b32 v60, 16, v94
    v_mfma_f32_16x16x32_bf16 v[164:167], v[32:35], a[64:67], v[164:167]
    ds_read_b64_tr_b16 v[30:31], v18 offset:5376
    v_lshlrev_b32 v64, 16, v95
    v_mfma_f32_16x16x32_bf16 v[168:171], v[32:35], a[72:75], v[168:171]
    ds_read_b64_tr_b16 v[36:37], v18 offset:0
    v_lshlrev_b32 v53, 16, v96
    v_mfma_f32_16x16x32_bf16 v[172:175], v[32:35], a[76:79], v[172:175]
    ds_read_b64_tr_b16 v[38:39], v18 offset:256
    v_lshlrev_b32 v57, 16, v97
    v_mfma_f32_16x16x32_bf16 v[176:179], v[32:35], a[32:35], v[176:179]
    ds_read_b128 a[68:71], v10 offset:3232
    v_lshlrev_b32 v61, 16, v98
    v_mfma_f32_16x16x32_bf16 v[180:183], v[32:35], a[28:31], v[180:183]
    ds_read_b128 a[140:143], v11 offset:3232
    v_lshlrev_b32 v65, 16, v99
    v_mfma_f32_16x16x32_bf16 v[184:187], v[40:43], a[136:139], v[184:187]
    ds_read_b128 a[228:231], v12 offset:3232
    v_and_b32 v54, s47, v92
    v_mfma_f32_16x16x32_bf16 v[188:191], v[40:43], a[132:135], v[188:191]
    ds_read_b128 v[76:79], v90 offset:0
    v_and_b32 v58, s47, v93
    v_mfma_f32_16x16x32_bf16 v[192:195], v[40:43], a[128:131], v[192:195]
    v_cvt_pk_bf16_f32 v84, v68, v69
    v_cvt_pk_bf16_f32 v85, v70, v71
    v_mfma_f32_16x16x32_bf16 v[196:199], v[40:43], a[164:167], v[196:199]
    v_cvt_pk_bf16_f32 v86, v72, v73
    v_cvt_pk_bf16_f32 v87, v74, v75
    v_mfma_f32_16x16x32_bf16 v[200:203], v[40:43], a[116:119], v[200:203]
    ds_write_b64 v89, v[84:85] offset:0
    ds_write_b64 v89, v[86:87] offset:18432
    v_mfma_f32_16x16x32_bf16 v[204:207], v[40:43], a[108:111], v[204:207]
    v_and_b32 v62, s47, v94
    v_and_b32 v66, s47, v95
    v_mfma_f32_16x16x32_bf16 v[208:211], v[40:43], a[104:107], v[208:211]
    v_and_b32 v55, s47, v96
    v_and_b32 v59, s47, v97
    v_mfma_f32_16x16x32_bf16 v[212:215], v[40:43], a[96:99], v[212:215]
    v_and_b32 v63, s47, v98
    v_and_b32 v67, s47, v99
    v_mfma_f32_16x16x32_bf16 v[216:219], v[40:43], a[92:95], v[216:219]
    v_add_f32 v52, v52, v53
    v_add_f32 v56, v56, v57
    v_mfma_f32_16x16x32_bf16 v[220:223], v[48:51], a[224:227], v[220:223]
    v_add_f32 v60, v60, v61
    v_add_f32 v64, v64, v65
    v_mfma_f32_16x16x32_bf16 v[224:227], v[48:51], a[220:223], v[224:227]
    v_add_f32 v54, v54, v55
    v_add_f32 v58, v58, v59
    v_mfma_f32_16x16x32_bf16 v[228:231], v[48:51], a[216:219], v[228:231]
    v_add_f32 v62, v62, v63
    v_add_f32 v66, v66, v67
    v_mfma_f32_16x16x32_bf16 v[232:235], v[48:51], a[192:195], v[232:235]
    v_cvt_pk_bf16_f32 v144, v52, v54
    v_cvt_pk_bf16_f32 v145, v56, v58
    v_mfma_f32_16x16x32_bf16 v[236:239], v[48:51], a[188:191], v[236:239]
    v_cvt_pk_bf16_f32 v146, v60, v62
    v_cvt_pk_bf16_f32 v147, v64, v66
    v_mfma_f32_16x16x32_bf16 v[240:243], v[48:51], a[184:187], v[240:243]
    v_mfma_f32_16x16x32_bf16 v[244:247], v[48:51], a[176:179], v[244:247]
    v_mfma_f32_16x16x32_bf16 v[248:251], v[48:51], a[172:175], v[248:251]
    v_mfma_f32_16x16x32_bf16 v[252:255], v[48:51], a[168:171], v[252:255]
    s_waitcnt lgkmcnt(3)
    v_mfma_f32_16x16x32_bf16 v[148:151], v[92:95], a[68:71], v[148:151]
    s_mov_b32 m0, s62
    s_add_u32 s54, s54, s55
    buffer_load_dwordx4 v16, s[20:23], s54 offen lds
    v_mfma_f32_16x16x32_bf16 v[152:155], v[92:95], a[56:59], v[152:155]
    s_mov_b32 m0, s57
    s_add_u32 s54, s54, s55
    buffer_load_dwordx4 v16, s[20:23], s54 offen lds
    v_mfma_f32_16x16x32_bf16 v[156:159], v[92:95], a[52:55], v[156:159]
    s_waitcnt lgkmcnt(2)
    v_mfma_f32_16x16x32_bf16 v[68:71], v[24:27], v[76:79], 0
    s_waitcnt vmcnt(5)
    ds_read_b64_tr_b16 v[32:33], v18 offset:1024
    v_lshlrev_b32 v52, 16, v28
    v_mfma_f32_16x16x32_bf16 v[160:163], v[92:95], a[48:51], v[160:163]
    ds_read_b64_tr_b16 v[34:35], v18 offset:1280
    v_lshlrev_b32 v56, 16, v29
    v_mfma_f32_16x16x32_bf16 v[164:167], v[92:95], a[60:63], v[164:167]
    ds_read_b64_tr_b16 v[40:41], v18 offset:2048
    v_lshlrev_b32 v60, 16, v30
    v_mfma_f32_16x16x32_bf16 v[168:171], v[92:95], a[64:67], v[168:171]
    ds_read_b64_tr_b16 v[42:43], v18 offset:2304
    v_lshlrev_b32 v64, 16, v31
    v_mfma_f32_16x16x32_bf16 v[172:175], v[92:95], a[72:75], v[172:175]
    ds_read_b128 a[80:83], v10 offset:2944
    v_lshlrev_b32 v53, 16, v36
    v_mfma_f32_16x16x32_bf16 v[176:179], v[92:95], a[76:79], v[176:179]
    ds_read_b128 a[144:147], v11 offset:2944
    v_lshlrev_b32 v57, 16, v37
    v_mfma_f32_16x16x32_bf16 v[180:183], v[92:95], a[32:35], v[180:183]
    ds_read_b128 a[232:235], v12 offset:2944
    s_mov_b32 s100, 2009088
    v_lshlrev_b32 v61, 16, v38
    v_mfma_f32_16x16x32_bf16 v[184:187], v[96:99], a[140:143], v[184:187]
    buffer_load_dword v21, v0, s[20:23], s100 offen
    v_mfma_f32_16x16x32_bf16 v[188:191], v[96:99], a[136:139], v[188:191]
    v_lshlrev_b32 v65, 16, v39
    v_and_b32 v54, s47, v28
    v_mfma_f32_16x16x32_bf16 v[192:195], v[96:99], a[132:135], v[192:195]
    v_and_b32 v58, s47, v29
    v_cvt_pk_bf16_f32 v84, v68, v69
    v_mfma_f32_16x16x32_bf16 v[196:199], v[96:99], a[128:131], v[196:199]
    v_cvt_pk_bf16_f32 v85, v70, v71
    ds_write_b64 v91, v[84:85] offset:0
    v_mfma_f32_16x16x32_bf16 v[200:203], v[96:99], a[164:167], v[200:203]
    v_and_b32 v62, s47, v30
    v_and_b32 v66, s47, v31
    v_mfma_f32_16x16x32_bf16 v[204:207], v[96:99], a[116:119], v[204:207]
    v_and_b32 v55, s47, v36
    v_and_b32 v59, s47, v37
    v_mfma_f32_16x16x32_bf16 v[208:211], v[96:99], a[108:111], v[208:211]
    v_and_b32 v63, s47, v38
    v_and_b32 v67, s47, v39
    v_mfma_f32_16x16x32_bf16 v[212:215], v[96:99], a[104:107], v[212:215]
    v_add_f32 v52, v52, v53
    v_add_f32 v56, v56, v57
    v_mfma_f32_16x16x32_bf16 v[216:219], v[96:99], a[96:99], v[216:219]
    v_add_f32 v60, v60, v61
    v_add_f32 v64, v64, v65
    v_mfma_f32_16x16x32_bf16 v[220:223], v[144:147], a[228:231], v[220:223]
    v_add_f32 v54, v54, v55
    v_add_f32 v58, v58, v59
    v_mfma_f32_16x16x32_bf16 v[224:227], v[144:147], a[224:227], v[224:227]
    v_add_f32 v62, v62, v63
    v_add_f32 v66, v66, v67
    v_mfma_f32_16x16x32_bf16 v[228:231], v[144:147], a[220:223], v[228:231]
    v_cvt_pk_bf16_f32 v44, v52, v54
    v_cvt_pk_bf16_f32 v45, v56, v58
    v_mfma_f32_16x16x32_bf16 v[232:235], v[144:147], a[216:219], v[232:235]
    v_cvt_pk_bf16_f32 v46, v60, v62
    v_cvt_pk_bf16_f32 v47, v64, v66
    v_mfma_f32_16x16x32_bf16 v[236:239], v[144:147], a[192:195], v[236:239]
    v_mfma_f32_16x16x32_bf16 v[240:243], v[144:147], a[188:191], v[240:243]
    v_mfma_f32_16x16x32_bf16 v[244:247], v[144:147], a[184:187], v[244:247]
    v_mfma_f32_16x16x32_bf16 v[248:251], v[144:147], a[176:179], v[248:251]
    v_mfma_f32_16x16x32_bf16 v[252:255], v[144:147], a[172:175], v[252:255]
    s_waitcnt lgkmcnt(1)
    v_mfma_f32_16x16x32_bf16 v[148:151], v[28:31], a[80:83], v[148:151]
    s_mov_b32 m0, s58
    s_add_u32 s54, s54, s55
    buffer_load_dwordx4 v16, s[20:23], s54 offen lds
    v_mfma_f32_16x16x32_bf16 v[152:155], v[28:31], a[68:71], v[152:155]
    s_mov_b32 m0, s59
    s_add_u32 s54, s54, s55
    buffer_load_dwordx4 v16, s[20:23], s54 offen lds
    v_mfma_f32_16x16x32_bf16 v[156:159], v[28:31], a[56:59], v[156:159]
    s_waitcnt vmcnt(5)
    ds_read_b64_tr_b16 v[92:93], v18 offset:3072
    v_lshlrev_b32 v52, 16, v32
    v_mfma_f32_16x16x32_bf16 v[160:163], v[28:31], a[52:55], v[160:163]
    ds_read_b64_tr_b16 v[94:95], v18 offset:3328
    v_lshlrev_b32 v56, 16, v33
    v_mfma_f32_16x16x32_bf16 v[164:167], v[28:31], a[48:51], v[164:167]
    ds_read_b64_tr_b16 v[96:97], v18 offset:4096
    v_lshlrev_b32 v60, 16, v34
    v_mfma_f32_16x16x32_bf16 v[168:171], v[28:31], a[60:63], v[168:171]
    ds_read_b64_tr_b16 v[98:99], v18 offset:4352
    v_lshlrev_b32 v64, 16, v35
    v_mfma_f32_16x16x32_bf16 v[172:175], v[28:31], a[64:67], v[172:175]
    ds_read_b128 a[24:27], v10 offset:2656
    v_lshlrev_b32 v53, 16, v40
    v_mfma_f32_16x16x32_bf16 v[176:179], v[28:31], a[72:75], v[176:179]
    ds_read_b128 a[148:151], v11 offset:2656
    v_lshlrev_b32 v57, 16, v41
    v_mfma_f32_16x16x32_bf16 v[180:183], v[28:31], a[76:79], v[180:183]
    ds_read_b128 a[236:239], v12 offset:2656
    v_lshlrev_b32 v61, 16, v42
    v_mfma_f32_16x16x32_bf16 v[184:187], v[36:39], a[144:147], v[184:187]
    ds_read_b128 a[12:15], v13 offset:4320
    v_lshlrev_b32 v65, 16, v43
    v_mfma_f32_16x16x32_bf16 v[188:191], v[36:39], a[140:143], v[188:191]
    ds_read_b128 a[4:7], v13 offset:4608
    v_and_b32 v54, s47, v32
    v_mfma_f32_16x16x32_bf16 v[192:195], v[36:39], a[136:139], v[192:195]
    v_and_b32 v58, s47, v33
    v_and_b32 v62, s47, v34
    v_mfma_f32_16x16x32_bf16 v[196:199], v[36:39], a[132:135], v[196:199]
    v_and_b32 v66, s47, v35
    v_and_b32 v55, s47, v40
    v_mfma_f32_16x16x32_bf16 v[200:203], v[36:39], a[128:131], v[200:203]
    v_and_b32 v59, s47, v41
    v_and_b32 v63, s47, v42
    v_mfma_f32_16x16x32_bf16 v[204:207], v[36:39], a[164:167], v[204:207]
    v_and_b32 v67, s47, v43
    v_add_f32 v52, v52, v53
    v_mfma_f32_16x16x32_bf16 v[208:211], v[36:39], a[116:119], v[208:211]
    v_add_f32 v56, v56, v57
    v_add_f32 v60, v60, v61
    v_mfma_f32_16x16x32_bf16 v[212:215], v[36:39], a[108:111], v[212:215]
    v_add_f32 v64, v64, v65
    v_add_f32 v54, v54, v55
    v_mfma_f32_16x16x32_bf16 v[216:219], v[36:39], a[104:107], v[216:219]
    v_add_f32 v58, v58, v59
    v_add_f32 v62, v62, v63
    v_mfma_f32_16x16x32_bf16 v[220:223], v[44:47], a[232:235], v[220:223]
    v_add_f32 v66, v66, v67
    v_cvt_pk_bf16_f32 v48, v52, v54
    v_mfma_f32_16x16x32_bf16 v[224:227], v[44:47], a[228:231], v[224:227]
    v_cvt_pk_bf16_f32 v49, v56, v58
    v_cvt_pk_bf16_f32 v50, v60, v62
    v_mfma_f32_16x16x32_bf16 v[228:231], v[44:47], a[224:227], v[228:231]
    v_cvt_pk_bf16_f32 v51, v64, v66
    v_mfma_f32_16x16x32_bf16 v[232:235], v[44:47], a[220:223], v[232:235]
    v_mfma_f32_16x16x32_bf16 v[236:239], v[44:47], a[216:219], v[236:239]
    v_mfma_f32_16x16x32_bf16 v[240:243], v[44:47], a[192:195], v[240:243]
    v_mfma_f32_16x16x32_bf16 v[244:247], v[44:47], a[188:191], v[244:247]
    v_mfma_f32_16x16x32_bf16 v[248:251], v[44:47], a[184:187], v[248:251]
    v_mfma_f32_16x16x32_bf16 v[252:255], v[44:47], a[176:179], v[252:255]
    s_waitcnt lgkmcnt(2)
    v_mfma_f32_16x16x32_bf16 v[148:151], v[32:35], a[24:27], v[148:151]
    s_mov_b32 m0, s60
    s_add_u32 s54, s54, s55
    buffer_load_dwordx4 v16, s[20:23], s54 offen lds
    v_mfma_f32_16x16x32_bf16 v[152:155], v[32:35], a[80:83], v[152:155]
    s_mov_b32 m0, s61
    s_add_u32 s54, s54, s55
    buffer_load_dwordx4 v16, s[20:23], s54 offen lds
    v_mfma_f32_16x16x32_bf16 v[156:159], v[32:35], a[68:71], v[156:159]
    s_waitcnt vmcnt(5)
    ds_read_b64_tr_b16 v[28:29], v18 offset:5120
    v_lshlrev_b32 v52, 16, v92
    v_mfma_f32_16x16x32_bf16 v[160:163], v[32:35], a[56:59], v[160:163]
    ds_read_b64_tr_b16 v[30:31], v18 offset:5376
    v_lshlrev_b32 v56, 16, v93
    v_mfma_f32_16x16x32_bf16 v[164:167], v[32:35], a[52:55], v[164:167]
    ds_read_b64_tr_b16 v[36:37], v18 offset:0
    v_lshlrev_b32 v60, 16, v94
    v_mfma_f32_16x16x32_bf16 v[168:171], v[32:35], a[48:51], v[168:171]
    ds_read_b64_tr_b16 v[38:39], v18 offset:256
    v_lshlrev_b32 v64, 16, v95
    v_mfma_f32_16x16x32_bf16 v[172:175], v[32:35], a[60:63], v[172:175]
    ds_read_b128 a[0:3], v10 offset:2368
    v_lshlrev_b32 v53, 16, v96
    v_mfma_f32_16x16x32_bf16 v[176:179], v[32:35], a[64:67], v[176:179]
    ds_read_b128 a[152:155], v11 offset:2368
    v_lshlrev_b32 v57, 16, v97
    v_mfma_f32_16x16x32_bf16 v[180:183], v[32:35], a[72:75], v[180:183]
    ds_read_b128 a[240:243], v12 offset:2368
    v_lshlrev_b32 v61, 16, v98
    v_mfma_f32_16x16x32_bf16 v[184:187], v[40:43], a[148:151], v[184:187]
    ds_read_b128 a[36:39], v13 offset:4896
    v_lshlrev_b32 v65, 16, v99
    v_mfma_f32_16x16x32_bf16 v[188:191], v[40:43], a[144:147], v[188:191]
    ds_read_b128 a[40:43], v13 offset:5184
    s_mov_b32 s51, 147456
    v_and_b32 v54, s47, v92
    v_mfma_f32_16x16x32_bf16 v[192:195], v[40:43], a[140:143], v[192:195]
    buffer_store_dwordx4 v[104:107], v101, s[32:35], s51 offen sc1
    v_mfma_f32_16x16x32_bf16 v[196:199], v[40:43], a[136:139], v[196:199]
    v_and_b32 v58, s47, v93
    v_and_b32 v62, s47, v94
    v_mfma_f32_16x16x32_bf16 v[200:203], v[40:43], a[132:135], v[200:203]
    v_and_b32 v66, s47, v95
    v_and_b32 v55, s47, v96
    v_mfma_f32_16x16x32_bf16 v[204:207], v[40:43], a[128:131], v[204:207]
    v_and_b32 v59, s47, v97
    v_and_b32 v63, s47, v98
    v_mfma_f32_16x16x32_bf16 v[208:211], v[40:43], a[164:167], v[208:211]
    v_and_b32 v67, s47, v99
    v_add_f32 v52, v52, v53
    v_mfma_f32_16x16x32_bf16 v[212:215], v[40:43], a[116:119], v[212:215]
    v_add_f32 v56, v56, v57
    v_add_f32 v60, v60, v61
    v_mfma_f32_16x16x32_bf16 v[216:219], v[40:43], a[108:111], v[216:219]
    v_add_f32 v64, v64, v65
    v_add_f32 v54, v54, v55
    v_mfma_f32_16x16x32_bf16 v[220:223], v[48:51], a[236:239], v[220:223]
    v_add_f32 v58, v58, v59
    v_add_f32 v62, v62, v63
    v_mfma_f32_16x16x32_bf16 v[224:227], v[48:51], a[232:235], v[224:227]
    v_add_f32 v66, v66, v67
    v_cvt_pk_bf16_f32 v144, v52, v54
    v_mfma_f32_16x16x32_bf16 v[228:231], v[48:51], a[228:231], v[228:231]
    v_cvt_pk_bf16_f32 v145, v56, v58
    v_cvt_pk_bf16_f32 v146, v60, v62
    v_mfma_f32_16x16x32_bf16 v[232:235], v[48:51], a[224:227], v[232:235]
    v_cvt_pk_bf16_f32 v147, v64, v66
    v_mfma_f32_16x16x32_bf16 v[236:239], v[48:51], a[220:223], v[236:239]
    v_mfma_f32_16x16x32_bf16 v[240:243], v[48:51], a[216:219], v[240:243]
    v_mfma_f32_16x16x32_bf16 v[244:247], v[48:51], a[192:195], v[244:247]
    v_mfma_f32_16x16x32_bf16 v[248:251], v[48:51], a[188:191], v[248:251]
    v_mfma_f32_16x16x32_bf16 v[252:255], v[48:51], a[184:187], v[252:255]
    s_waitcnt lgkmcnt(2)
    v_mfma_f32_16x16x32_bf16 v[148:151], v[92:95], a[0:3], v[148:151]
    s_mov_b32 m0, s62
    s_add_u32 s54, s54, s55
    buffer_load_dwordx4 v16, s[20:23], s54 offen lds
    v_mfma_f32_16x16x32_bf16 v[152:155], v[92:95], a[24:27], v[152:155]
    s_mov_b32 m0, s57
    s_add_u32 s54, s54, s55
    buffer_load_dwordx4 v16, s[20:23], s54 offen lds
    v_mfma_f32_16x16x32_bf16 v[156:159], v[92:95], a[80:83], v[156:159]
    s_waitcnt vmcnt(5)
    ds_read_b64_tr_b16 v[32:33], v18 offset:1024
    v_lshlrev_b32 v52, 16, v28
    v_mfma_f32_16x16x32_bf16 v[160:163], v[92:95], a[68:71], v[160:163]
    ds_read_b64_tr_b16 v[34:35], v18 offset:1280
    v_lshlrev_b32 v56, 16, v29
    v_mfma_f32_16x16x32_bf16 v[164:167], v[92:95], a[56:59], v[164:167]
    ds_read_b64_tr_b16 v[40:41], v18 offset:2048
    v_lshlrev_b32 v60, 16, v30
    v_mfma_f32_16x16x32_bf16 v[168:171], v[92:95], a[52:55], v[168:171]
    ds_read_b64_tr_b16 v[42:43], v18 offset:2304
    v_lshlrev_b32 v64, 16, v31
    v_mfma_f32_16x16x32_bf16 v[172:175], v[92:95], a[48:51], v[172:175]
    ds_read_b128 a[44:47], v10 offset:2080
    v_lshlrev_b32 v53, 16, v36
    v_mfma_f32_16x16x32_bf16 v[176:179], v[92:95], a[60:63], v[176:179]
    ds_read_b128 a[156:159], v11 offset:2080
    v_lshlrev_b32 v57, 16, v37
    v_mfma_f32_16x16x32_bf16 v[180:183], v[92:95], a[64:67], v[180:183]
    ds_read_b128 a[244:247], v12 offset:2080
    v_lshlrev_b32 v61, 16, v38
    v_mfma_f32_16x16x32_bf16 v[184:187], v[96:99], a[152:155], v[184:187]
    ds_read_b128 a[8:11], v13 offset:5472
    v_lshlrev_b32 v65, 16, v39
    v_mfma_f32_16x16x32_bf16 v[188:191], v[96:99], a[148:151], v[188:191]
    ds_read_b128 a[16:19], v13 offset:5760
    v_and_b32 v54, s47, v28
    v_mfma_f32_16x16x32_bf16 v[192:195], v[96:99], a[144:147], v[192:195]
    v_and_b32 v58, s47, v29
    v_and_b32 v62, s47, v30
    v_mfma_f32_16x16x32_bf16 v[196:199], v[96:99], a[140:143], v[196:199]
    v_and_b32 v66, s47, v31
    v_and_b32 v55, s47, v36
    v_mfma_f32_16x16x32_bf16 v[200:203], v[96:99], a[136:139], v[200:203]
    v_and_b32 v59, s47, v37
    v_and_b32 v63, s47, v38
    v_mfma_f32_16x16x32_bf16 v[204:207], v[96:99], a[132:135], v[204:207]
    v_and_b32 v67, s47, v39
    v_add_f32 v52, v52, v53
    v_mfma_f32_16x16x32_bf16 v[208:211], v[96:99], a[128:131], v[208:211]
    v_add_f32 v56, v56, v57
    v_add_f32 v60, v60, v61
    v_mfma_f32_16x16x32_bf16 v[212:215], v[96:99], a[164:167], v[212:215]
    v_add_f32 v64, v64, v65
    v_add_f32 v54, v54, v55
    v_mfma_f32_16x16x32_bf16 v[216:219], v[96:99], a[116:119], v[216:219]
    v_add_f32 v58, v58, v59
    v_add_f32 v62, v62, v63
    v_mfma_f32_16x16x32_bf16 v[220:223], v[144:147], a[240:243], v[220:223]
    v_add_f32 v66, v66, v67
    v_cvt_pk_bf16_f32 v44, v52, v54
    v_mfma_f32_16x16x32_bf16 v[224:227], v[144:147], a[236:239], v[224:227]
    v_cvt_pk_bf16_f32 v45, v56, v58
    v_cvt_pk_bf16_f32 v46, v60, v62
    v_mfma_f32_16x16x32_bf16 v[228:231], v[144:147], a[232:235], v[228:231]
    v_cvt_pk_bf16_f32 v47, v64, v66
    v_mfma_f32_16x16x32_bf16 v[232:235], v[144:147], a[228:231], v[232:235]
    v_mfma_f32_16x16x32_bf16 v[236:239], v[144:147], a[224:227], v[236:239]
    v_mfma_f32_16x16x32_bf16 v[240:243], v[144:147], a[220:223], v[240:243]
    v_mfma_f32_16x16x32_bf16 v[244:247], v[144:147], a[216:219], v[244:247]
    v_mfma_f32_16x16x32_bf16 v[248:251], v[144:147], a[192:195], v[248:251]
    v_mfma_f32_16x16x32_bf16 v[252:255], v[144:147], a[188:191], v[252:255]
    s_waitcnt lgkmcnt(2)
    v_mfma_f32_16x16x32_bf16 v[148:151], v[28:31], a[44:47], v[148:151]
    s_mov_b32 m0, s58
    s_add_u32 s54, s54, s55
    buffer_load_dwordx4 v16, s[20:23], s54 offen lds
    v_mfma_f32_16x16x32_bf16 v[152:155], v[28:31], a[0:3], v[152:155]
    s_mov_b32 m0, s59
    s_add_u32 s54, s54, s55
    buffer_load_dwordx4 v16, s[20:23], s54 offen lds
    v_mfma_f32_16x16x32_bf16 v[156:159], v[28:31], a[24:27], v[156:159]
    s_waitcnt vmcnt(5)
    ds_read_b64_tr_b16 v[92:93], v18 offset:3072
    v_lshlrev_b32 v52, 16, v32
    v_mfma_f32_16x16x32_bf16 v[160:163], v[28:31], a[80:83], v[160:163]
    ds_read_b64_tr_b16 v[94:95], v18 offset:3328
    v_lshlrev_b32 v56, 16, v33
    v_mfma_f32_16x16x32_bf16 v[164:167], v[28:31], a[68:71], v[164:167]
    ds_read_b64_tr_b16 v[96:97], v18 offset:4096
    v_lshlrev_b32 v60, 16, v34
    v_mfma_f32_16x16x32_bf16 v[168:171], v[28:31], a[56:59], v[168:171]
    ds_read_b64_tr_b16 v[98:99], v18 offset:4352
    v_lshlrev_b32 v64, 16, v35
    v_mfma_f32_16x16x32_bf16 v[172:175], v[28:31], a[52:55], v[172:175]
    ds_read_b128 a[20:23], v10 offset:1792
    v_lshlrev_b32 v53, 16, v40
    v_mfma_f32_16x16x32_bf16 v[176:179], v[28:31], a[48:51], v[176:179]
    ds_read_b128 a[160:163], v11 offset:1792
    v_lshlrev_b32 v57, 16, v41
    v_mfma_f32_16x16x32_bf16 v[180:183], v[28:31], a[60:63], v[180:183]
    ds_read_b128 a[248:251], v12 offset:1792
    v_lshlrev_b32 v61, 16, v42
    v_mfma_f32_16x16x32_bf16 v[184:187], v[36:39], a[156:159], v[184:187]
    ds_read_b128 a[28:31], v13 offset:6048
    v_lshlrev_b32 v65, 16, v43
    v_mfma_f32_16x16x32_bf16 v[188:191], v[36:39], a[152:155], v[188:191]
    ds_read_b128 a[32:35], v13 offset:6336
    s_mov_b32 s100, 0
    v_and_b32 v54, s47, v32
    v_mfma_f32_16x16x32_bf16 v[192:195], v[36:39], a[148:151], v[192:195]
    buffer_load_dword v21, v102, s[20:23], s100 offen
    v_mfma_f32_16x16x32_bf16 v[196:199], v[36:39], a[144:147], v[196:199]
    v_and_b32 v58, s47, v33
    v_and_b32 v62, s47, v34
    v_mfma_f32_16x16x32_bf16 v[200:203], v[36:39], a[140:143], v[200:203]
    v_and_b32 v66, s47, v35
    v_and_b32 v55, s47, v40
    v_mfma_f32_16x16x32_bf16 v[204:207], v[36:39], a[136:139], v[204:207]
    v_and_b32 v59, s47, v41
    v_and_b32 v63, s47, v42
    v_mfma_f32_16x16x32_bf16 v[208:211], v[36:39], a[132:135], v[208:211]
    v_and_b32 v67, s47, v43
    v_add_f32 v52, v52, v53
    v_mfma_f32_16x16x32_bf16 v[212:215], v[36:39], a[128:131], v[212:215]
    v_add_f32 v56, v56, v57
    v_add_f32 v60, v60, v61
    v_mfma_f32_16x16x32_bf16 v[216:219], v[36:39], a[164:167], v[216:219]
    v_add_f32 v64, v64, v65
    v_add_f32 v54, v54, v55
    v_mfma_f32_16x16x32_bf16 v[220:223], v[44:47], a[244:247], v[220:223]
    v_add_f32 v58, v58, v59
    v_add_f32 v62, v62, v63
    v_mfma_f32_16x16x32_bf16 v[224:227], v[44:47], a[240:243], v[224:227]
    v_add_f32 v66, v66, v67
    v_cvt_pk_bf16_f32 v48, v52, v54
    v_mfma_f32_16x16x32_bf16 v[228:231], v[44:47], a[236:239], v[228:231]
    v_cvt_pk_bf16_f32 v49, v56, v58
    v_cvt_pk_bf16_f32 v50, v60, v62
    v_mfma_f32_16x16x32_bf16 v[232:235], v[44:47], a[232:235], v[232:235]
    v_cvt_pk_bf16_f32 v51, v64, v66
    s_mul_i32 s4, s36, 165888
    v_mfma_f32_16x16x32_bf16 v[236:239], v[44:47], a[228:231], v[236:239]
    s_mul_i32 s5, s37, 18432
    s_add_u32 s4, s4, s5
    v_mfma_f32_16x16x32_bf16 v[240:243], v[44:47], a[224:227], v[240:243]
    s_lshl_b32 s5, s44, 10
    s_add_u32 s4, s4, s5
    v_mfma_f32_16x16x32_bf16 v[244:247], v[44:47], a[220:223], v[244:247]
    s_add_u32 s4, s4, 1048576
    s_lshl_b32 s5, s43, 12
    v_mfma_f32_16x16x32_bf16 v[248:251], v[44:47], a[216:219], v[248:251]
    s_add_u32 s5, s5, s4
    v_mfma_f32_16x16x32_bf16 v[252:255], v[44:47], a[192:195], v[252:255]
    s_waitcnt lgkmcnt(2)
    v_mfma_f32_16x16x32_bf16 v[148:151], v[32:35], a[20:23], v[148:151]
    s_mov_b32 m0, s60
    s_add_u32 s54, s54, s55
    buffer_load_dwordx4 v16, s[20:23], s54 offen lds
    v_mfma_f32_16x16x32_bf16 v[152:155], v[32:35], a[44:47], v[152:155]
    s_mov_b32 m0, s61
    s_add_u32 s54, s54, s55
    buffer_load_dwordx4 v16, s[20:23], s54 offen lds
    v_mfma_f32_16x16x32_bf16 v[156:159], v[32:35], a[0:3], v[156:159]
    s_waitcnt vmcnt(5)
    ds_read_b64_tr_b16 v[28:29], v18 offset:5120
    v_lshlrev_b32 v52, 16, v92
    v_mfma_f32_16x16x32_bf16 v[160:163], v[32:35], a[24:27], v[160:163]
    ds_read_b64_tr_b16 v[30:31], v18 offset:5376
    v_lshlrev_b32 v56, 16, v93
    v_mfma_f32_16x16x32_bf16 v[164:167], v[32:35], a[80:83], v[164:167]
    ds_read_b64_tr_b16 v[36:37], v18 offset:0
    v_lshlrev_b32 v60, 16, v94
    v_mfma_f32_16x16x32_bf16 v[168:171], v[32:35], a[68:71], v[168:171]
    ds_read_b64_tr_b16 v[38:39], v18 offset:256
    v_lshlrev_b32 v64, 16, v95
    v_mfma_f32_16x16x32_bf16 v[172:175], v[32:35], a[56:59], v[172:175]
    ds_read_b128 a[76:79], v10 offset:1504
    v_lshlrev_b32 v53, 16, v96
    v_mfma_f32_16x16x32_bf16 v[176:179], v[32:35], a[52:55], v[176:179]
    ds_read_b128 a[112:115], v11 offset:1504
    v_lshlrev_b32 v57, 16, v97
    v_mfma_f32_16x16x32_bf16 v[180:183], v[32:35], a[48:51], v[180:183]
    ds_read_b128 a[200:203], v12 offset:1504
    v_lshlrev_b32 v61, 16, v98
    v_mfma_f32_16x16x32_bf16 v[184:187], v[40:43], a[160:163], v[184:187]
    ds_read_b128 a[72:75], v13 offset:6624
    v_lshlrev_b32 v65, 16, v99
    v_mfma_f32_16x16x32_bf16 v[188:191], v[40:43], a[156:159], v[188:191]
    v_and_b32 v54, s47, v92
    v_and_b32 v58, s47, v93
    v_mfma_f32_16x16x32_bf16 v[192:195], v[40:43], a[152:155], v[192:195]
    v_and_b32 v62, s47, v94
    v_and_b32 v66, s47, v95
    v_mfma_f32_16x16x32_bf16 v[196:199], v[40:43], a[148:151], v[196:199]
    v_and_b32 v55, s47, v96
    v_and_b32 v59, s47, v97
    v_mfma_f32_16x16x32_bf16 v[200:203], v[40:43], a[144:147], v[200:203]
    v_and_b32 v63, s47, v98
    v_and_b32 v67, s47, v99
    v_mfma_f32_16x16x32_bf16 v[204:207], v[40:43], a[140:143], v[204:207]
    v_add_f32 v52, v52, v53
    v_add_f32 v56, v56, v57
    v_mfma_f32_16x16x32_bf16 v[208:211], v[40:43], a[136:139], v[208:211]
    v_add_f32 v60, v60, v61
    v_add_f32 v64, v64, v65
    v_mfma_f32_16x16x32_bf16 v[212:215], v[40:43], a[132:135], v[212:215]
    v_add_f32 v54, v54, v55
    v_add_f32 v58, v58, v59
    v_mfma_f32_16x16x32_bf16 v[216:219], v[40:43], a[128:131], v[216:219]
    v_add_f32 v62, v62, v63
    v_add_f32 v66, v66, v67
    v_mfma_f32_16x16x32_bf16 v[220:223], v[48:51], a[248:251], v[220:223]
    v_cvt_pk_bf16_f32 v144, v52, v54
    v_cvt_pk_bf16_f32 v145, v56, v58
    v_mfma_f32_16x16x32_bf16 v[224:227], v[48:51], a[244:247], v[224:227]
    v_cvt_pk_bf16_f32 v146, v60, v62
    v_cvt_pk_bf16_f32 v147, v64, v66
    v_mfma_f32_16x16x32_bf16 v[228:231], v[48:51], a[240:243], v[228:231]
    v_lshlrev_b32 v4, 8, v3
    v_lshlrev_b32 v5, 4, v2
    v_mfma_f32_16x16x32_bf16 v[232:235], v[48:51], a[236:239], v[232:235]
    v_add3_u32 v128, v4, v5, s5
    v_lshrrev_b32 v6, 1, v3
    v_mfma_f32_16x16x32_bf16 v[236:239], v[48:51], a[232:235], v[236:239]
    v_lshlrev_b32 v6, 10, v6
    v_add_u32 v6, v6, v128
    v_mfma_f32_16x16x32_bf16 v[240:243], v[48:51], a[228:231], v[240:243]
    v_add_u32 v129, 8704, v6
    s_lshl_b32 s5, s43, 8
    v_mfma_f32_16x16x32_bf16 v[244:247], v[48:51], a[224:227], v[244:247]
    v_mfma_f32_16x16x32_bf16 v[248:251], v[48:51], a[220:223], v[248:251]
    v_mfma_f32_16x16x32_bf16 v[252:255], v[48:51], a[216:219], v[252:255]
    s_waitcnt lgkmcnt(1)
    v_mfma_f32_16x16x32_bf16 v[148:151], v[92:95], a[76:79], v[148:151]
    s_mov_b32 m0, s62
    s_add_u32 s54, s54, s55
    buffer_load_dwordx4 v16, s[20:23], s54 offen lds
    v_mfma_f32_16x16x32_bf16 v[152:155], v[92:95], a[20:23], v[152:155]
    s_mov_b32 m0, s57
    s_add_u32 s54, s54, s55
    buffer_load_dwordx4 v16, s[20:23], s54 offen lds
    v_mfma_f32_16x16x32_bf16 v[156:159], v[92:95], a[44:47], v[156:159]
    s_waitcnt vmcnt(5)
    ds_read_b64_tr_b16 v[32:33], v18 offset:1024
    v_lshlrev_b32 v52, 16, v28
    v_mfma_f32_16x16x32_bf16 v[160:163], v[92:95], a[0:3], v[160:163]
    ds_read_b64_tr_b16 v[34:35], v18 offset:1280
    v_lshlrev_b32 v56, 16, v29
    v_mfma_f32_16x16x32_bf16 v[164:167], v[92:95], a[24:27], v[164:167]
    ds_read_b64_tr_b16 v[40:41], v18 offset:2048
    v_lshlrev_b32 v60, 16, v30
    v_mfma_f32_16x16x32_bf16 v[168:171], v[92:95], a[80:83], v[168:171]
    ds_read_b64_tr_b16 v[42:43], v18 offset:2304
    v_lshlrev_b32 v64, 16, v31
    v_mfma_f32_16x16x32_bf16 v[172:175], v[92:95], a[68:71], v[172:175]
    ds_read_b128 a[64:67], v10 offset:1216
    v_lshlrev_b32 v53, 16, v36
    v_mfma_f32_16x16x32_bf16 v[176:179], v[92:95], a[56:59], v[176:179]
    ds_read_b128 a[100:103], v11 offset:1216
    v_lshlrev_b32 v57, 16, v37
    v_mfma_f32_16x16x32_bf16 v[180:183], v[92:95], a[52:55], v[180:183]
    ds_read_b128 a[196:199], v12 offset:1216
    v_lshlrev_b32 v61, 16, v38
    v_mfma_f32_16x16x32_bf16 v[184:187], v[96:99], a[112:115], v[184:187]
    ds_read_b128 a[88:91], v14 offset:4320
    v_lshlrev_b32 v65, 16, v39
    v_mfma_f32_16x16x32_bf16 v[188:191], v[96:99], a[160:163], v[188:191]
    ds_read_b128 a[124:127], v14 offset:4608
    v_and_b32 v54, s47, v28
    v_mfma_f32_16x16x32_bf16 v[192:195], v[96:99], a[156:159], v[192:195]
    v_and_b32 v58, s47, v29
    v_and_b32 v62, s47, v30
    v_mfma_f32_16x16x32_bf16 v[196:199], v[96:99], a[152:155], v[196:199]
    v_and_b32 v66, s47, v31
    v_and_b32 v55, s47, v36
    v_mfma_f32_16x16x32_bf16 v[200:203], v[96:99], a[148:151], v[200:203]
    v_and_b32 v59, s47, v37
    v_and_b32 v63, s47, v38
    v_mfma_f32_16x16x32_bf16 v[204:207], v[96:99], a[144:147], v[204:207]
    v_and_b32 v67, s47, v39
    v_add_f32 v52, v52, v53
    v_mfma_f32_16x16x32_bf16 v[208:211], v[96:99], a[140:143], v[208:211]
    v_add_f32 v56, v56, v57
    v_add_f32 v60, v60, v61
    v_mfma_f32_16x16x32_bf16 v[212:215], v[96:99], a[136:139], v[212:215]
    v_add_f32 v64, v64, v65
    v_add_f32 v54, v54, v55
    v_mfma_f32_16x16x32_bf16 v[216:219], v[96:99], a[132:135], v[216:219]
    v_add_f32 v58, v58, v59
    v_add_f32 v62, v62, v63
    v_mfma_f32_16x16x32_bf16 v[220:223], v[144:147], a[200:203], v[220:223]
    v_add_f32 v66, v66, v67
    v_cvt_pk_bf16_f32 v44, v52, v54
    v_mfma_f32_16x16x32_bf16 v[224:227], v[144:147], a[248:251], v[224:227]
    v_cvt_pk_bf16_f32 v45, v56, v58
    v_cvt_pk_bf16_f32 v46, v60, v62
    v_mfma_f32_16x16x32_bf16 v[228:231], v[144:147], a[244:247], v[228:231]
    v_cvt_pk_bf16_f32 v47, v64, v66
    s_add_u32 s5, s5, s4
    v_mfma_f32_16x16x32_bf16 v[232:235], v[144:147], a[240:243], v[232:235]
    v_lshlrev_b32 v6, 2, v3
    v_add3_u32 v6, v5, v6, s5
    v_mfma_f32_16x16x32_bf16 v[236:239], v[144:147], a[236:239], v[236:239]
    v_add_u32 v130, 8192, v6
    v_add_u32 v131, 16896, v6
    v_mfma_f32_16x16x32_bf16 v[240:243], v[144:147], a[232:235], v[240:243]
    v_lshlrev_b32 v4, 3, v3
    v_lshrrev_b32 v5, 2, v2
    v_mfma_f32_16x16x32_bf16 v[244:247], v[144:147], a[228:231], v[244:247]
    v_add_u32 v4, v4, v5
    v_mfma_f32_16x16x32_bf16 v[248:251], v[144:147], a[224:227], v[248:251]
    v_mfma_f32_16x16x32_bf16 v[252:255], v[144:147], a[220:223], v[252:255]
    s_waitcnt lgkmcnt(2)
    v_mfma_f32_16x16x32_bf16 v[148:151], v[28:31], a[64:67], v[148:151]
    s_mov_b32 m0, s58
    s_add_u32 s54, s54, s55
    buffer_load_dwordx4 v16, s[20:23], s54 offen lds
    v_mfma_f32_16x16x32_bf16 v[152:155], v[28:31], a[76:79], v[152:155]
    s_waitcnt vmcnt(3)
    ds_read_b64_tr_b16 v[92:93], v18 offset:3072
    v_lshlrev_b32 v52, 16, v32
    v_mfma_f32_16x16x32_bf16 v[156:159], v[28:31], a[20:23], v[156:159]
    ds_read_b64_tr_b16 v[94:95], v18 offset:3328
    v_lshlrev_b32 v56, 16, v33
    v_mfma_f32_16x16x32_bf16 v[160:163], v[28:31], a[44:47], v[160:163]
    ds_read_b64_tr_b16 v[96:97], v18 offset:4096
    v_lshlrev_b32 v60, 16, v34
    v_mfma_f32_16x16x32_bf16 v[164:167], v[28:31], a[0:3], v[164:167]
    ds_read_b64_tr_b16 v[98:99], v18 offset:4352
    v_lshlrev_b32 v64, 16, v35
    v_mfma_f32_16x16x32_bf16 v[168:171], v[28:31], a[24:27], v[168:171]
    ds_read_b128 a[60:63], v10 offset:928
    v_lshlrev_b32 v53, 16, v40
    v_mfma_f32_16x16x32_bf16 v[172:175], v[28:31], a[80:83], v[172:175]
    ds_read_b128 a[120:123], v11 offset:928
    v_lshlrev_b32 v57, 16, v41
    v_mfma_f32_16x16x32_bf16 v[176:179], v[28:31], a[68:71], v[176:179]
    ds_read_b128 a[180:183], v12 offset:928
    v_lshlrev_b32 v61, 16, v42
    v_mfma_f32_16x16x32_bf16 v[180:183], v[28:31], a[56:59], v[180:183]
    ds_read_b128 a[84:87], v14 offset:4896
    v_lshlrev_b32 v65, 16, v43
    v_mfma_f32_16x16x32_bf16 v[184:187], v[36:39], a[100:103], v[184:187]
    ds_read_b128 a[92:95], v14 offset:5184
    v_and_b32 v54, s47, v32
    v_mfma_f32_16x16x32_bf16 v[188:191], v[36:39], a[112:115], v[188:191]
    v_and_b32 v58, s47, v33
    v_and_b32 v62, s47, v34
    v_mfma_f32_16x16x32_bf16 v[192:195], v[36:39], a[160:163], v[192:195]
    v_and_b32 v66, s47, v35
    v_and_b32 v55, s47, v40
    v_mfma_f32_16x16x32_bf16 v[196:199], v[36:39], a[156:159], v[196:199]
    v_and_b32 v59, s47, v41
    v_and_b32 v63, s47, v42
    v_mfma_f32_16x16x32_bf16 v[200:203], v[36:39], a[152:155], v[200:203]
    v_and_b32 v67, s47, v43
    v_add_f32 v52, v52, v53
    v_mfma_f32_16x16x32_bf16 v[204:207], v[36:39], a[148:151], v[204:207]
    v_add_f32 v56, v56, v57
    v_add_f32 v60, v60, v61
    v_mfma_f32_16x16x32_bf16 v[208:211], v[36:39], a[144:147], v[208:211]
    v_add_f32 v64, v64, v65
    v_add_f32 v54, v54, v55
    v_mfma_f32_16x16x32_bf16 v[212:215], v[36:39], a[140:143], v[212:215]
    v_add_f32 v58, v58, v59
    v_add_f32 v62, v62, v63
    v_mfma_f32_16x16x32_bf16 v[216:219], v[36:39], a[136:139], v[216:219]
    v_add_f32 v66, v66, v67
    v_cvt_pk_bf16_f32 v48, v52, v54
    v_mfma_f32_16x16x32_bf16 v[220:223], v[44:47], a[196:199], v[220:223]
    v_cvt_pk_bf16_f32 v49, v56, v58
    v_cvt_pk_bf16_f32 v50, v60, v62
    v_mfma_f32_16x16x32_bf16 v[224:227], v[44:47], a[200:203], v[224:227]
    v_cvt_pk_bf16_f32 v51, v64, v66
    v_mul_u32_u24 v4, 288, v4
    v_mfma_f32_16x16x32_bf16 v[228:231], v[44:47], a[248:251], v[228:231]
    v_and_b32 v6, 3, v2
    v_lshlrev_b32 v6, 3, v6
    v_mfma_f32_16x16x32_bf16 v[232:235], v[44:47], a[244:247], v[232:235]
    s_lshl_b32 s4, s43, 7
    s_add_u32 s4, s4, 36864
    v_mfma_f32_16x16x32_bf16 v[236:239], v[44:47], a[240:243], v[236:239]
    v_add3_u32 v132, v4, v6, s4
    v_lshlrev_b32 v4, 2, v3
    v_mfma_f32_16x16x32_bf16 v[240:243], v[44:47], a[236:239], v[240:243]
    v_add_u32 v4, v4, v5
    v_mfma_f32_16x16x32_bf16 v[244:247], v[44:47], a[232:235], v[244:247]
    v_mfma_f32_16x16x32_bf16 v[248:251], v[44:47], a[228:231], v[248:251]
    v_mfma_f32_16x16x32_bf16 v[252:255], v[44:47], a[224:227], v[252:255]
    s_waitcnt lgkmcnt(2)
    v_mfma_f32_16x16x32_bf16 v[148:151], v[32:35], a[60:63], v[148:151]
    s_mov_b32 m0, s59
    s_mov_b32 s54, 0
    buffer_load_dwordx4 v17, s[20:23], s54 offen lds
    v_mfma_f32_16x16x32_bf16 v[152:155], v[32:35], a[64:67], v[152:155]
    s_mov_b32 m0, s60
    s_add_u32 s54, s54, s55
    buffer_load_dwordx4 v17, s[20:23], s54 offen lds
    v_mfma_f32_16x16x32_bf16 v[156:159], v[32:35], a[76:79], v[156:159]
    s_waitcnt vmcnt(3)
    ds_read_b64_tr_b16 v[28:29], v18 offset:5120
    v_lshlrev_b32 v52, 16, v92
    v_mfma_f32_16x16x32_bf16 v[160:163], v[32:35], a[20:23], v[160:163]
    ds_read_b64_tr_b16 v[30:31], v18 offset:5376
    v_lshlrev_b32 v56, 16, v93
    v_mfma_f32_16x16x32_bf16 v[164:167], v[32:35], a[44:47], v[164:167]
    ds_read_b64_tr_b16 v[36:37], v18 offset:0
    v_lshlrev_b32 v60, 16, v94
    v_mfma_f32_16x16x32_bf16 v[168:171], v[32:35], a[0:3], v[168:171]
    ds_read_b64_tr_b16 v[38:39], v18 offset:256
    v_lshlrev_b32 v64, 16, v95
    v_mfma_f32_16x16x32_bf16 v[172:175], v[32:35], a[24:27], v[172:175]
    ds_read_b128 a[48:51], v10 offset:640
    v_lshlrev_b32 v53, 16, v96
    v_mfma_f32_16x16x32_bf16 v[176:179], v[32:35], a[80:83], v[176:179]
    ds_read_b128 a[96:99], v11 offset:640
    v_lshlrev_b32 v57, 16, v97
    v_mfma_f32_16x16x32_bf16 v[180:183], v[32:35], a[68:71], v[180:183]
    ds_read_b128 a[212:215], v12 offset:640
    v_lshlrev_b32 v61, 16, v98
    v_mfma_f32_16x16x32_bf16 v[184:187], v[40:43], a[120:123], v[184:187]
    ds_read_b128 a[104:107], v14 offset:5472
    v_lshlrev_b32 v65, 16, v99
    v_mfma_f32_16x16x32_bf16 v[188:191], v[40:43], a[100:103], v[188:191]
    ds_read_b128 a[108:111], v14 offset:5760
    v_and_b32 v54, s47, v92
    v_mfma_f32_16x16x32_bf16 v[192:195], v[40:43], a[112:115], v[192:195]
    v_and_b32 v58, s47, v93
    v_and_b32 v62, s47, v94
    v_mfma_f32_16x16x32_bf16 v[196:199], v[40:43], a[160:163], v[196:199]
    v_and_b32 v66, s47, v95
    v_and_b32 v55, s47, v96
    v_mfma_f32_16x16x32_bf16 v[200:203], v[40:43], a[156:159], v[200:203]
    v_and_b32 v59, s47, v97
    v_and_b32 v63, s47, v98
    v_mfma_f32_16x16x32_bf16 v[204:207], v[40:43], a[152:155], v[204:207]
    v_and_b32 v67, s47, v99
    v_add_f32 v52, v52, v53
    v_mfma_f32_16x16x32_bf16 v[208:211], v[40:43], a[148:151], v[208:211]
    v_add_f32 v56, v56, v57
    v_add_f32 v60, v60, v61
    v_mfma_f32_16x16x32_bf16 v[212:215], v[40:43], a[144:147], v[212:215]
    v_add_f32 v64, v64, v65
    v_add_f32 v54, v54, v55
    v_mfma_f32_16x16x32_bf16 v[216:219], v[40:43], a[140:143], v[216:219]
    v_add_f32 v58, v58, v59
    v_add_f32 v62, v62, v63
    v_mfma_f32_16x16x32_bf16 v[220:223], v[48:51], a[180:183], v[220:223]
    v_add_f32 v66, v66, v67
    v_cvt_pk_bf16_f32 v144, v52, v54
    v_mfma_f32_16x16x32_bf16 v[224:227], v[48:51], a[196:199], v[224:227]
    v_cvt_pk_bf16_f32 v145, v56, v58
    v_cvt_pk_bf16_f32 v146, v60, v62
    v_mfma_f32_16x16x32_bf16 v[228:231], v[48:51], a[200:203], v[228:231]
    v_cvt_pk_bf16_f32 v147, v64, v66
    v_mul_u32_u24 v4, 288, v4
    v_mfma_f32_16x16x32_bf16 v[232:235], v[48:51], a[248:251], v[232:235]
    s_add_u32 s4, s4, 36864
    v_add3_u32 v133, v4, v6, s4
    v_mfma_f32_16x16x32_bf16 v[236:239], v[48:51], a[244:247], v[236:239]
    s_mul_i32 s4, s44, 4608
    s_add_u32 s4, s4, 86016
    v_mfma_f32_16x16x32_bf16 v[240:243], v[48:51], a[240:243], v[240:243]
    s_lshl_b32 s5, s43, 11
    s_add_u32 s5, s5, s4
    v_mfma_f32_16x16x32_bf16 v[244:247], v[48:51], a[236:239], v[244:247]
    v_lshlrev_b32 v4, 4, v1
    v_mfma_f32_16x16x32_bf16 v[248:251], v[48:51], a[232:235], v[248:251]
    v_mfma_f32_16x16x32_bf16 v[252:255], v[48:51], a[228:231], v[252:255]
    s_waitcnt lgkmcnt(2)
    v_mfma_f32_16x16x32_bf16 v[148:151], v[92:95], a[48:51], v[148:151]
    s_waitcnt lgkmcnt(0)
    s_barrier
    s_mov_b32 m0, s61
    v_lshlrev_b32 v52, 16, v28
    v_lshlrev_b32 v56, 16, v29
    v_mfma_f32_16x16x32_bf16 v[152:155], v[92:95], a[60:63], v[152:155]
    s_add_u32 s54, s54, s56
    buffer_load_dwordx4 v17, s[20:23], s54 offen lds
    v_mfma_f32_16x16x32_bf16 v[156:159], v[92:95], a[64:67], v[156:159]
    s_mov_b32 m0, s62
    s_add_u32 s54, s54, s55
    buffer_load_dwordx4 v17, s[20:23], s54 offen lds
    v_mfma_f32_16x16x32_bf16 v[160:163], v[92:95], a[76:79], v[160:163]
    s_waitcnt vmcnt(4)
    ds_read_b64_tr_b16 v[32:33], v18 offset:1024
    v_lshlrev_b32 v60, 16, v30
    v_mfma_f32_16x16x32_bf16 v[164:167], v[92:95], a[20:23], v[164:167]
    ds_read_b64_tr_b16 v[34:35], v18 offset:1280
    v_lshlrev_b32 v64, 16, v31
    v_mfma_f32_16x16x32_bf16 v[168:171], v[92:95], a[44:47], v[168:171]
    ds_read_b128 a[52:55], v10 offset:352
    v_lshlrev_b32 v53, 16, v36
    v_mfma_f32_16x16x32_bf16 v[172:175], v[92:95], a[0:3], v[172:175]
    ds_read_b128 a[116:119], v11 offset:352
    v_lshlrev_b32 v57, 16, v37
    v_mfma_f32_16x16x32_bf16 v[176:179], v[92:95], a[24:27], v[176:179]
    ds_read_b128 a[208:211], v12 offset:352
    v_lshlrev_b32 v61, 16, v38
    v_mfma_f32_16x16x32_bf16 v[180:183], v[92:95], a[80:83], v[180:183]
    ds_read_b128 a[164:167], v14 offset:6048
    v_lshlrev_b32 v65, 16, v39
    v_mfma_f32_16x16x32_bf16 v[184:187], v[96:99], a[96:99], v[184:187]
    ds_read_b128 a[128:131], v14 offset:6336
    v_and_b32 v54, s47, v28
    v_mfma_f32_16x16x32_bf16 v[188:191], v[96:99], a[120:123], v[188:191]
    ds_read_b128 a[204:207], v15 offset:4320
    v_and_b32 v58, s47, v29
    v_mfma_f32_16x16x32_bf16 v[192:195], v[96:99], a[100:103], v[192:195]
    ds_read_b128 a[168:171], v15 offset:4608
    v_and_b32 v62, s47, v30
    v_mfma_f32_16x16x32_bf16 v[196:199], v[96:99], a[112:115], v[196:199]
    ds_read_b128 a[172:175], v15 offset:4896
    v_and_b32 v66, s47, v31
    v_mfma_f32_16x16x32_bf16 v[200:203], v[96:99], a[160:163], v[200:203]
    buffer_store_dword v8, v22, s[32:35], 0 offen sc1
    v_mfma_f32_16x16x32_bf16 v[204:207], v[96:99], a[156:159], v[204:207]
    v_and_b32 v55, s47, v36
    v_and_b32 v59, s47, v37
    v_mfma_f32_16x16x32_bf16 v[208:211], v[96:99], a[152:155], v[208:211]
    v_and_b32 v63, s47, v38
    v_and_b32 v67, s47, v39
    v_mfma_f32_16x16x32_bf16 v[212:215], v[96:99], a[148:151], v[212:215]
    v_add_f32 v52, v52, v53
    v_add_f32 v56, v56, v57
    v_mfma_f32_16x16x32_bf16 v[216:219], v[96:99], a[144:147], v[216:219]
    v_add_f32 v60, v60, v61
    v_add_f32 v64, v64, v65
    v_mfma_f32_16x16x32_bf16 v[220:223], v[144:147], a[212:215], v[220:223]
    v_add_f32 v54, v54, v55
    v_add_f32 v58, v58, v59
    v_mfma_f32_16x16x32_bf16 v[224:227], v[144:147], a[180:183], v[224:227]
    v_add_f32 v62, v62, v63
    v_add_f32 v66, v66, v67
    v_mfma_f32_16x16x32_bf16 v[228:231], v[144:147], a[196:199], v[228:231]
    v_cvt_pk_bf16_f32 v44, v52, v54
    v_cvt_pk_bf16_f32 v45, v56, v58
    v_mfma_f32_16x16x32_bf16 v[232:235], v[144:147], a[200:203], v[232:235]
    v_cvt_pk_bf16_f32 v46, v60, v62
    v_cvt_pk_bf16_f32 v47, v64, v66
    v_mfma_f32_16x16x32_bf16 v[236:239], v[144:147], a[248:251], v[236:239]
    v_add_u32 v134, s5, v4
    v_add_u32 v136, s4, v4
    v_mfma_f32_16x16x32_bf16 v[240:243], v[144:147], a[244:247], v[240:243]
    s_cmp_eq_u32 s42, 3
    s_cselect_b32 s7, 2048, 0
    s_lshl_b32 s6, s42, 13
    v_mfma_f32_16x16x32_bf16 v[244:247], v[144:147], a[240:243], v[244:247]
    s_add_u32 s6, s6, s7
    v_add_u32 v140, s6, v4
    v_mfma_f32_16x16x32_bf16 v[248:251], v[144:147], a[236:239], v[248:251]
    v_mfma_f32_16x16x32_bf16 v[252:255], v[144:147], a[232:235], v[252:255]
    s_waitcnt lgkmcnt(5)
    v_mfma_f32_16x16x32_bf16 v[148:151], v[28:31], a[52:55], v[148:151]
    s_mov_b32 m0, s57
    s_add_u32 s54, s54, s56
    buffer_load_dwordx4 v17, s[20:23], s54 offen lds
    v_mfma_f32_16x16x32_bf16 v[152:155], v[28:31], a[48:51], v[152:155]
    s_mov_b32 m0, s58
    s_add_u32 s54, s54, s55
    buffer_load_dwordx4 v17, s[20:23], s54 offen lds
    v_mfma_f32_16x16x32_bf16 v[156:159], v[28:31], a[60:63], v[156:159]
    s_waitcnt vmcnt(5)
    ds_read_b64_tr_b16 v[92:93], v18 offset:2048
    s_xor_b32 s6, s42, 2
    v_mfma_f32_16x16x32_bf16 v[160:163], v[28:31], a[64:67], v[160:163]
    ds_read_b64_tr_b16 v[94:95], v18 offset:2304
    s_cmp_eq_u32 s6, 3
    s_cselect_b32 s7, 2048, 0
    v_mfma_f32_16x16x32_bf16 v[164:167], v[28:31], a[76:79], v[164:167]
    ds_read_b64_tr_b16 v[96:97], v18 offset:3072
    s_lshl_b32 s6, s6, 13
    v_mfma_f32_16x16x32_bf16 v[168:171], v[28:31], a[20:23], v[168:171]
    ds_read_b64_tr_b16 v[98:99], v18 offset:3328
    s_add_u32 s6, s6, s7
    v_mfma_f32_16x16x32_bf16 v[172:175], v[28:31], a[44:47], v[172:175]
    ds_read_b128 a[56:59], v10 offset:64
    v_add_u32 v141, s6, v4
    v_mfma_f32_16x16x32_bf16 v[176:179], v[28:31], a[0:3], v[176:179]
    ds_read_b128 a[176:179], v12 offset:64
    s_lshl_b32 s6, s44, 10
    v_mfma_f32_16x16x32_bf16 v[180:183], v[28:31], a[24:27], v[180:183]
    ds_read_b128 a[132:135], v14 offset:6624
    v_subrev_u32 v100, s6, v100
    v_mfma_f32_16x16x32_bf16 v[184:187], v[36:39], a[116:119], v[184:187]
    ds_read_b128 a[184:187], v15 offset:5184
    v_subrev_u32 v101, s6, v101
    v_mfma_f32_16x16x32_bf16 v[188:191], v[36:39], a[96:99], v[188:191]
    ds_read_b128 a[188:191], v15 offset:5472
    v_lshrrev_b32 v6, 1, v3
    v_mfma_f32_16x16x32_bf16 v[192:195], v[36:39], a[120:123], v[192:195]
    ds_read_b128 a[192:195], v15 offset:5760
    s_lshl_b32 s5, s43, 1
    v_mfma_f32_16x16x32_bf16 v[196:199], v[36:39], a[100:103], v[196:199]
    v_add_u32 v6, s5, v6
    v_lshlrev_b32 v6, 7, v6
    v_mfma_f32_16x16x32_bf16 v[200:203], v[36:39], a[112:115], v[200:203]
    v_lshlrev_b32 v7, 3, v2
    v_add_u32 v6, v6, v7
    v_mfma_f32_16x16x32_bf16 v[204:207], v[36:39], a[160:163], v[204:207]
    v_and_b32 v7, 1, v3
    v_lshlrev_b32 v7, 2, v7
    v_mfma_f32_16x16x32_bf16 v[208:211], v[36:39], a[156:159], v[208:211]
    s_add_u32 s5, s4, 4096
    v_add3_u32 v135, v6, v7, s5
    v_mfma_f32_16x16x32_bf16 v[212:215], v[36:39], a[152:155], v[212:215]
    v_lshlrev_b32 v6, 3, v1
    v_add_u32 v137, s5, v6
    v_mfma_f32_16x16x32_bf16 v[216:219], v[36:39], a[148:151], v[216:219]
    s_add_u32 s4, s45, s37
    v_mul_u32_u24 v4, 9, v2
    v_mfma_f32_16x16x32_bf16 v[220:223], v[44:47], a[208:211], v[220:223]
    v_add_u32 v4, s4, v4
    s_mul_i32 s5, s38, 143
    v_mfma_f32_16x16x32_bf16 v[224:227], v[44:47], a[212:215], v[224:227]
    v_cmp_gt_i32 s[6:7], s5, v4
    v_lshlrev_b32 v5, 2, v4
    v_mfma_f32_16x16x32_bf16 v[228:231], v[44:47], a[180:183], v[228:231]
    s_lshl_b32 s5, s44, 1
    s_add_u32 s5, s5, s40
    v_mfma_f32_16x16x32_bf16 v[232:235], v[44:47], a[196:199], v[232:235]
    v_add_u32 v5, s5, v5
    v_mul_u32_u24 v5, 288, v5
    v_mfma_f32_16x16x32_bf16 v[236:239], v[44:47], a[200:203], v[236:239]
    v_and_b32 v6, 1, v3
    v_lshlrev_b32 v6, 5, v6
    v_mfma_f32_16x16x32_bf16 v[240:243], v[44:47], a[248:251], v[240:243]
    v_lshrrev_b32 v7, 1, v3
    v_lshlrev_b32 v7, 4, v7
    v_mfma_f32_16x16x32_bf16 v[244:247], v[44:47], a[244:247], v[244:247]
    v_add3_u32 v5, v5, v6, v7
    s_lshl_b32 s5, s43, 7
    v_mfma_f32_16x16x32_bf16 v[248:251], v[44:47], a[240:243], v[248:251]
    v_add_u32 v5, s5, v5
    v_mov_b32 v6, 0x7fffffff
    v_mfma_f32_16x16x32_bf16 v[252:255], v[44:47], a[236:239], v[252:255]
    v_cndmask_b32 v138, v5, v6, s[6:7]
    v_and_b32 v7, 1, v3
    v_cmp_eq_u32 vcc, 1, v7
    v_mov_b32 v20, 1.0
    v_mov_b32 v21, 1.0
    v_cndmask_b32 v139, v138, v6, vcc
    s_waitcnt lgkmcnt(4)
    v_mfma_f32_16x16x32_bf16 v[148:151], v[32:35], a[56:59], v[148:151]
    s_mov_b32 m0, s59
    s_add_u32 s54, s54, s56
    buffer_load_dwordx4 v17, s[20:23], s54 offen lds
    v_mfma_f32_16x16x32_bf16 v[152:155], v[32:35], a[52:55], v[152:155]
    s_mov_b32 m0, s60
    s_add_u32 s54, s54, s55
    buffer_load_dwordx4 v17, s[20:23], s54 offen lds
    v_mfma_f32_16x16x32_bf16 v[156:159], v[32:35], a[48:51], v[156:159]
    s_waitcnt vmcnt(5)
    ds_read_b64_tr_b16 v[28:29], v18 offset:4096
    v_lshlrev_b32 v52, 16, v92
    v_mfma_f32_16x16x32_bf16 v[160:163], v[32:35], a[60:63], v[160:163]
    ds_read_b64_tr_b16 v[30:31], v18 offset:4352
    v_lshlrev_b32 v56, 16, v93
    v_mfma_f32_16x16x32_bf16 v[164:167], v[32:35], a[64:67], v[164:167]
    ds_read_b64_tr_b16 v[36:37], v18 offset:5120
    v_lshlrev_b32 v60, 16, v94
    v_mfma_f32_16x16x32_bf16 v[168:171], v[32:35], a[76:79], v[168:171]
    ds_read_b64_tr_b16 v[38:39], v18 offset:5376
    v_lshlrev_b32 v64, 16, v95
    v_mfma_f32_16x16x32_bf16 v[172:175], v[32:35], a[20:23], v[172:175]
    ds_read_b128 a[216:219], v15 offset:6048
    v_lshlrev_b32 v53, 16, v96
    v_mfma_f32_16x16x32_bf16 v[176:179], v[32:35], a[44:47], v[176:179]
    ds_read_b128 a[220:223], v15 offset:6336
    v_lshlrev_b32 v57, 16, v97
    v_mfma_f32_16x16x32_bf16 v[180:183], v[32:35], a[0:3], v[180:183]
    ds_read_b128 a[224:227], v15 offset:6624
    v_lshlrev_b32 v61, 16, v98
    v_mfma_f32_16x16x32_bf16 v[220:223], v[32:35], a[176:179], v[220:223]
    v_lshlrev_b32 v65, 16, v99
    v_and_b32 v54, s47, v92
    v_mfma_f32_16x16x32_bf16 v[224:227], v[32:35], a[208:211], v[224:227]
    v_and_b32 v58, s47, v93
    v_and_b32 v62, s47, v94
    v_mfma_f32_16x16x32_bf16 v[228:231], v[32:35], a[212:215], v[228:231]
    v_and_b32 v66, s47, v95
    v_and_b32 v55, s47, v96
    v_mfma_f32_16x16x32_bf16 v[232:235], v[32:35], a[180:183], v[232:235]
    v_and_b32 v59, s47, v97
    v_and_b32 v63, s47, v98
    v_mfma_f32_16x16x32_bf16 v[236:239], v[32:35], a[196:199], v[236:239]
    v_and_b32 v67, s47, v99
    v_add_f32 v52, v52, v53
    v_mfma_f32_16x16x32_bf16 v[240:243], v[32:35], a[200:203], v[240:243]
    v_add_f32 v56, v56, v57
    v_add_f32 v60, v60, v61
    v_mfma_f32_16x16x32_bf16 v[244:247], v[32:35], a[248:251], v[244:247]
    v_add_f32 v64, v64, v65
    v_add_f32 v54, v54, v55
    v_mfma_f32_16x16x32_bf16 v[248:251], v[32:35], a[244:247], v[248:251]
    v_add_f32 v58, v58, v59
    v_add_f32 v62, v62, v63
    v_mfma_f32_16x16x32_bf16 v[252:255], v[32:35], a[240:243], v[252:255]
    v_add_f32 v66, v66, v67
    v_cvt_pk_bf16_f32 v144, v52, v54
    v_cvt_pk_bf16_f32 v145, v56, v58
    v_cvt_pk_bf16_f32 v146, v60, v62
    v_cvt_pk_bf16_f32 v147, v64, v66
    s_waitcnt lgkmcnt(0)
    v_mfma_f32_16x16x32_bf16 v[148:151], v[92:95], a[12:15], v[148:151]
    s_waitcnt vmcnt(2)
    ds_read_b64_tr_b16 v[32:33], v18 offset:0
    v_lshlrev_b32 v52, 16, v28
    v_mfma_f32_16x16x32_bf16 v[152:155], v[92:95], a[4:7], v[152:155]
    ds_read_b64_tr_b16 v[34:35], v18 offset:256
    v_lshlrev_b32 v56, 16, v29
    v_mfma_f32_16x16x32_bf16 v[156:159], v[92:95], a[36:39], v[156:159]
    ds_read_b64_tr_b16 v[40:41], v18 offset:1024
    v_lshlrev_b32 v60, 16, v30
    v_mfma_f32_16x16x32_bf16 v[160:163], v[92:95], a[40:43], v[160:163]
    ds_read_b64_tr_b16 v[42:43], v18 offset:1280
    v_lshlrev_b32 v64, 16, v31
    v_mfma_f32_16x16x32_bf16 v[164:167], v[92:95], a[8:11], v[164:167]
    ds_read_b128 a[68:71], v13 offset:3744
    v_lshlrev_b32 v53, 16, v36
    v_mfma_f32_16x16x32_bf16 v[168:171], v[92:95], a[16:19], v[168:171]
    ds_read_b128 a[80:83], v13 offset:4032
    v_lshlrev_b32 v57, 16, v37
    v_mfma_f32_16x16x32_bf16 v[172:175], v[92:95], a[28:31], v[172:175]
    ds_read_b128 a[136:139], v14 offset:3744
    v_lshlrev_b32 v61, 16, v38
    v_mfma_f32_16x16x32_bf16 v[176:179], v[92:95], a[32:35], v[176:179]
    ds_read_b128 a[140:143], v14 offset:4032
    v_lshlrev_b32 v65, 16, v39
    v_mfma_f32_16x16x32_bf16 v[180:183], v[92:95], a[72:75], v[180:183]
    ds_read_b128 a[228:231], v15 offset:3744
    v_and_b32 v54, s47, v28
    v_mfma_f32_16x16x32_bf16 v[184:187], v[96:99], a[88:91], v[184:187]
    ds_read_b128 a[232:235], v15 offset:4032
    v_and_b32 v58, s47, v29
    v_mfma_f32_16x16x32_bf16 v[188:191], v[96:99], a[124:127], v[188:191]
    v_and_b32 v62, s47, v30
    v_and_b32 v66, s47, v31
    v_mfma_f32_16x16x32_bf16 v[192:195], v[96:99], a[84:87], v[192:195]
    v_and_b32 v55, s47, v36
    v_and_b32 v59, s47, v37
    v_mfma_f32_16x16x32_bf16 v[196:199], v[96:99], a[92:95], v[196:199]
    v_and_b32 v63, s47, v38
    v_and_b32 v67, s47, v39
    v_mfma_f32_16x16x32_bf16 v[200:203], v[96:99], a[104:107], v[200:203]
    v_add_f32 v52, v52, v53
    v_add_f32 v56, v56, v57
    v_mfma_f32_16x16x32_bf16 v[204:207], v[96:99], a[108:111], v[204:207]
    v_add_f32 v60, v60, v61
    v_add_f32 v64, v64, v65
    v_mfma_f32_16x16x32_bf16 v[208:211], v[96:99], a[164:167], v[208:211]
    v_add_f32 v54, v54, v55
    v_add_f32 v58, v58, v59
    v_mfma_f32_16x16x32_bf16 v[212:215], v[96:99], a[128:131], v[212:215]
    v_add_f32 v62, v62, v63
    v_add_f32 v66, v66, v67
    v_mfma_f32_16x16x32_bf16 v[216:219], v[96:99], a[132:135], v[216:219]
    v_cvt_pk_bf16_f32 v44, v52, v54
    v_cvt_pk_bf16_f32 v45, v56, v58
    v_mfma_f32_16x16x32_bf16 v[220:223], v[144:147], a[204:207], v[220:223]
    v_cvt_pk_bf16_f32 v46, v60, v62
    v_cvt_pk_bf16_f32 v47, v64, v66
    v_mfma_f32_16x16x32_bf16 v[224:227], v[144:147], a[168:171], v[224:227]
    s_lshl_b32 s4, s36, 8
    s_add_u32 s4, s4, 128
    v_mfma_f32_16x16x32_bf16 v[228:231], v[144:147], a[172:175], v[228:231]
    v_mov_b32 v4, s4
    v_or_b32 v5, s42, v1
    v_mfma_f32_16x16x32_bf16 v[232:235], v[144:147], a[184:187], v[232:235]
    v_or_b32 v5, s37, v5
    v_cmp_eq_u32 vcc, 0, v5
    v_mfma_f32_16x16x32_bf16 v[236:239], v[144:147], a[188:191], v[236:239]
    v_mov_b32 v10, 0xc038aa3b
    v_mov_b32 v11, 0xc038aa3b
    v_mfma_f32_16x16x32_bf16 v[240:243], v[144:147], a[192:195], v[240:243]
    v_cndmask_b32 v142, v6, v4, vcc
    v_mov_b32 v16, 0xbfb8aa3b
    v_mfma_f32_16x16x32_bf16 v[244:247], v[144:147], a[216:219], v[244:247]
    v_mfma_f32_16x16x32_bf16 v[248:251], v[144:147], a[220:223], v[248:251]
    v_mfma_f32_16x16x32_bf16 v[252:255], v[144:147], a[224:227], v[252:255]
    s_waitcnt lgkmcnt(0)
    v_mfma_f32_16x16x32_bf16 v[148:151], v[28:31], a[68:71], v[148:151]
    s_waitcnt vmcnt(0)
    ds_read_b64_tr_b16 v[92:93], v18 offset:2048
    v_lshlrev_b32 v52, 16, v32
    v_mfma_f32_16x16x32_bf16 v[152:155], v[28:31], a[80:83], v[152:155]
    ds_read_b64_tr_b16 v[94:95], v18 offset:2304
    v_lshlrev_b32 v56, 16, v33
    v_mfma_f32_16x16x32_bf16 v[156:159], v[28:31], a[12:15], v[156:159]
    ds_read_b64_tr_b16 v[96:97], v18 offset:3072
    v_lshlrev_b32 v60, 16, v34
    v_mfma_f32_16x16x32_bf16 v[160:163], v[28:31], a[4:7], v[160:163]
    ds_read_b64_tr_b16 v[98:99], v18 offset:3328
    v_lshlrev_b32 v64, 16, v35
    v_mfma_f32_16x16x32_bf16 v[164:167], v[28:31], a[36:39], v[164:167]
    ds_read_b128 a[24:27], v13 offset:3168
    v_lshlrev_b32 v53, 16, v40
    v_mfma_f32_16x16x32_bf16 v[168:171], v[28:31], a[40:43], v[168:171]
    ds_read_b128 a[0:3], v13 offset:3456
    v_lshlrev_b32 v57, 16, v41
    v_mfma_f32_16x16x32_bf16 v[172:175], v[28:31], a[8:11], v[172:175]
    ds_read_b128 a[144:147], v14 offset:3168
    v_lshlrev_b32 v61, 16, v42
    v_mfma_f32_16x16x32_bf16 v[176:179], v[28:31], a[16:19], v[176:179]
    ds_read_b128 a[148:151], v14 offset:3456
    v_lshlrev_b32 v65, 16, v43
    v_mfma_f32_16x16x32_bf16 v[180:183], v[28:31], a[28:31], v[180:183]
    ds_read_b128 a[236:239], v15 offset:3168
    v_and_b32 v54, s47, v32
    v_mfma_f32_16x16x32_bf16 v[184:187], v[36:39], a[136:139], v[184:187]
    ds_read_b128 a[240:243], v15 offset:3456
    v_and_b32 v58, s47, v33
    v_mfma_f32_16x16x32_bf16 v[188:191], v[36:39], a[140:143], v[188:191]
    buffer_load_dword v9, v23, s[32:35], 0 offen sc1
    v_mfma_f32_16x16x32_bf16 v[192:195], v[36:39], a[88:91], v[192:195]
    v_and_b32 v62, s47, v34
    v_and_b32 v66, s47, v35
    v_mfma_f32_16x16x32_bf16 v[196:199], v[36:39], a[124:127], v[196:199]
    v_and_b32 v55, s47, v40
    v_and_b32 v59, s47, v41
    v_mfma_f32_16x16x32_bf16 v[200:203], v[36:39], a[84:87], v[200:203]
    v_and_b32 v63, s47, v42
    v_and_b32 v67, s47, v43
    v_mfma_f32_16x16x32_bf16 v[204:207], v[36:39], a[92:95], v[204:207]
    v_add_f32 v52, v52, v53
    v_add_f32 v56, v56, v57
    v_mfma_f32_16x16x32_bf16 v[208:211], v[36:39], a[104:107], v[208:211]
    v_add_f32 v60, v60, v61
    v_add_f32 v64, v64, v65
    v_mfma_f32_16x16x32_bf16 v[212:215], v[36:39], a[108:111], v[212:215]
    v_add_f32 v54, v54, v55
    v_add_f32 v58, v58, v59
    v_mfma_f32_16x16x32_bf16 v[216:219], v[36:39], a[164:167], v[216:219]
    v_add_f32 v62, v62, v63
    v_add_f32 v66, v66, v67
    v_mfma_f32_16x16x32_bf16 v[220:223], v[44:47], a[228:231], v[220:223]
    v_cvt_pk_bf16_f32 v48, v52, v54
    v_cvt_pk_bf16_f32 v49, v56, v58
    v_mfma_f32_16x16x32_bf16 v[224:227], v[44:47], a[232:235], v[224:227]
    v_cvt_pk_bf16_f32 v50, v60, v62
    v_cvt_pk_bf16_f32 v51, v64, v66
    v_mfma_f32_16x16x32_bf16 v[228:231], v[44:47], a[204:207], v[228:231]
    v_mov_b32 v17, 0xbfb8aa3b
    s_mov_b32 s8, 0x42700000
    v_mfma_f32_16x16x32_bf16 v[232:235], v[44:47], a[168:171], v[232:235]
    v_mfma_f32_16x16x32_bf16 v[236:239], v[44:47], a[172:175], v[236:239]
    v_mfma_f32_16x16x32_bf16 v[240:243], v[44:47], a[184:187], v[240:243]
    v_mfma_f32_16x16x32_bf16 v[244:247], v[44:47], a[188:191], v[244:247]
    v_mfma_f32_16x16x32_bf16 v[248:251], v[44:47], a[192:195], v[248:251]
    v_mfma_f32_16x16x32_bf16 v[252:255], v[44:47], a[216:219], v[252:255]
    s_waitcnt lgkmcnt(0)
    s_mul_i32 s51, s42, 11264
    s_add_u32 s53, s51, 36864
    v_lshlrev_b32 v103, 4, v1
    v_mfma_f32_16x16x32_bf16 v[148:151], v[32:35], a[24:27], v[148:151]
    ds_read_b128 a[44:47], v13 offset:2592
    v_lshlrev_b32 v52, 16, v92
    v_mfma_f32_16x16x32_bf16 v[152:155], v[32:35], a[0:3], v[152:155]
    ds_read_b128 a[20:23], v13 offset:2880
    v_lshlrev_b32 v56, 16, v93
    v_mfma_f32_16x16x32_bf16 v[156:159], v[32:35], a[68:71], v[156:159]
    ds_read_b128 a[152:155], v14 offset:2592
    v_lshlrev_b32 v60, 16, v94
    v_mfma_f32_16x16x32_bf16 v[160:163], v[32:35], a[80:83], v[160:163]
    ds_read_b128 a[156:159], v14 offset:2880
    v_lshlrev_b32 v64, 16, v95
    v_mfma_f32_16x16x32_bf16 v[164:167], v[32:35], a[12:15], v[164:167]
    ds_read_b128 a[244:247], v15 offset:2592
    v_lshlrev_b32 v53, 16, v96
    v_mfma_f32_16x16x32_bf16 v[168:171], v[32:35], a[4:7], v[168:171]
    ds_read_b128 a[248:251], v15 offset:2880
    v_lshlrev_b32 v57, 16, v97
    v_mfma_f32_16x16x32_bf16 v[172:175], v[32:35], a[36:39], v[172:175]
    v_lshlrev_b32 v61, 16, v98
    v_lshlrev_b32 v65, 16, v99
    v_mfma_f32_16x16x32_bf16 v[176:179], v[32:35], a[40:43], v[176:179]
    v_and_b32 v54, s47, v92
    v_and_b32 v58, s47, v93
    v_mfma_f32_16x16x32_bf16 v[180:183], v[32:35], a[8:11], v[180:183]
    v_and_b32 v62, s47, v94
    v_and_b32 v66, s47, v95
    v_mfma_f32_16x16x32_bf16 v[184:187], v[40:43], a[144:147], v[184:187]
    v_and_b32 v55, s47, v96
    v_and_b32 v59, s47, v97
    v_mfma_f32_16x16x32_bf16 v[188:191], v[40:43], a[148:151], v[188:191]
    v_and_b32 v63, s47, v98
    v_and_b32 v67, s47, v99
    v_mfma_f32_16x16x32_bf16 v[192:195], v[40:43], a[136:139], v[192:195]
    v_add_f32 v52, v52, v53
    v_add_f32 v56, v56, v57
    v_mfma_f32_16x16x32_bf16 v[196:199], v[40:43], a[140:143], v[196:199]
    v_add_f32 v60, v60, v61
    v_add_f32 v64, v64, v65
    v_mfma_f32_16x16x32_bf16 v[200:203], v[40:43], a[88:91], v[200:203]
    v_add_f32 v54, v54, v55
    v_add_f32 v58, v58, v59
    v_mfma_f32_16x16x32_bf16 v[204:207], v[40:43], a[124:127], v[204:207]
    v_add_f32 v62, v62, v63
    v_add_f32 v66, v66, v67
    v_mfma_f32_16x16x32_bf16 v[208:211], v[40:43], a[84:87], v[208:211]
    v_cvt_pk_bf16_f32 v144, v52, v54
    v_cvt_pk_bf16_f32 v145, v56, v58
    v_mfma_f32_16x16x32_bf16 v[212:215], v[40:43], a[92:95], v[212:215]
    v_cvt_pk_bf16_f32 v146, v60, v62
    v_cvt_pk_bf16_f32 v147, v64, v66
    v_mfma_f32_16x16x32_bf16 v[216:219], v[40:43], a[104:107], v[216:219]
    s_waitcnt lgkmcnt(0)
    v_mfma_f32_16x16x32_bf16 v[148:151], v[92:95], a[44:47], v[148:151]
    s_barrier
    v_mfma_f32_16x16x32_bf16 v[152:155], v[92:95], a[20:23], v[152:155]
    s_add_u32 m0, s53, 0
    s_add_u32 s52, s51, 0
    buffer_load_dwordx4 v103, s[24:27], s52 offen offset:0 lds
    v_mfma_f32_16x16x32_bf16 v[156:159], v[92:95], a[24:27], v[156:159]
    v_mfma_f32_16x16x32_bf16 v[160:163], v[92:95], a[0:3], v[160:163]
    v_mfma_f32_16x16x32_bf16 v[164:167], v[92:95], a[68:71], v[164:167]
    buffer_load_dwordx4 v103, s[24:27], s52 offen offset:1024 lds
    v_mfma_f32_16x16x32_bf16 v[168:171], v[92:95], a[80:83], v[168:171]
    v_mfma_f32_16x16x32_bf16 v[172:175], v[92:95], a[12:15], v[172:175]
    v_mfma_f32_16x16x32_bf16 v[176:179], v[92:95], a[4:7], v[176:179]
    buffer_load_dwordx4 v103, s[24:27], s52 offen offset:2048 lds
    v_mfma_f32_16x16x32_bf16 v[180:183], v[92:95], a[36:39], v[180:183]
    v_mfma_f32_16x16x32_bf16 v[184:187], v[96:99], a[152:155], v[184:187]
    v_mfma_f32_16x16x32_bf16 v[188:191], v[96:99], a[156:159], v[188:191]
    buffer_load_dwordx4 v103, s[24:27], s52 offen offset:3072 lds
    v_mfma_f32_16x16x32_bf16 v[192:195], v[96:99], a[144:147], v[192:195]
    v_mfma_f32_16x16x32_bf16 v[196:199], v[96:99], a[148:151], v[196:199]
    v_mfma_f32_16x16x32_bf16 v[200:203], v[96:99], a[136:139], v[200:203]
    v_mfma_f32_16x16x32_bf16 v[204:207], v[96:99], a[140:143], v[204:207]
    v_mfma_f32_16x16x32_bf16 v[208:211], v[96:99], a[88:91], v[208:211]
    v_mfma_f32_16x16x32_bf16 v[212:215], v[96:99], a[124:127], v[212:215]
    v_mfma_f32_16x16x32_bf16 v[216:219], v[96:99], a[84:87], v[216:219]
    s_waitcnt vmcnt(4)
    v_cmp_ne_u32 vcc, v8, v9
    s_nop 4
    s_cbranch_vccz L_flagok
    s_mov_b32 s63, 0
L_flagpoll:
    buffer_load_dword v9, v23, s[32:35], 0 offen sc1
    s_add_u32 s63, s63, 1
    s_waitcnt vmcnt(0)
    v_cmp_ne_u32 vcc, v8, v9
    s_sleep 1
    s_nop 3
    s_cbranch_vccz L_flagok
    s_cmp_lt_u32 s63, 0x40000
    s_cbranch_scc1 L_flagpoll
L_flagok:
    s_cmp_eq_u32 s44, 0
    s_cbranch_scc0 L_red1
    v_mfma_f32_16x16x32_bf16 v[220:223], v[48:51], a[236:239], v[220:223]
    s_add_u32 m0, s53, 4096
    s_add_u32 s52, s51, 4096
    buffer_load_dwordx4 v103, s[24:27], s52 offen offset:0 lds
    v_mfma_f32_16x16x32_bf16 v[224:227], v[48:51], a[240:243], v[224:227]
    v_pk_add_f32 v[24:25], v[168:169], v[200:201]
    v_pk_add_f32 v[26:27], v[170:171], v[202:203]
    v_mfma_f32_16x16x32_bf16 v[228:231], v[48:51], a[228:231], v[228:231]
    ds_write_b128 v140, v[24:27] offset:0
    v_pk_add_f32 v[56:57], v[152:153], v[184:185]
    v_mfma_f32_16x16x32_bf16 v[232:235], v[48:51], a[232:235], v[232:235]
    buffer_load_dwordx4 v103, s[24:27], s52 offen offset:1024 lds
    v_mfma_f32_16x16x32_bf16 v[236:239], v[48:51], a[204:207], v[236:239]
    v_pk_add_f32 v[58:59], v[154:155], v[186:187]
    v_pk_add_f32 v[28:29], v[172:173], v[204:205]
    v_mfma_f32_16x16x32_bf16 v[240:243], v[48:51], a[168:171], v[240:243]
    v_pk_add_f32 v[30:31], v[174:175], v[206:207]
    ds_write_b128 v140, v[28:31] offset:1024
    v_mfma_f32_16x16x32_bf16 v[244:247], v[48:51], a[172:175], v[244:247]
    buffer_load_dwordx4 v103, s[24:27], s52 offen offset:2048 lds
    v_mfma_f32_16x16x32_bf16 v[248:251], v[48:51], a[184:187], v[248:251]
    v_pk_add_f32 v[60:61], v[156:157], v[188:189]
    v_pk_add_f32 v[62:63], v[158:159], v[190:191]
    v_mfma_f32_16x16x32_bf16 v[252:255], v[48:51], a[188:191], v[252:255]
    v_pk_add_f32 v[32:33], v[176:177], v[208:209]
    v_pk_add_f32 v[34:35], v[178:179], v[210:211]
    v_mfma_f32_16x16x32_bf16 v[220:223], v[144:147], a[244:247], v[220:223]
    buffer_load_dwordx4 v103, s[24:27], s52 offen offset:3072 lds
    v_mfma_f32_16x16x32_bf16 v[224:227], v[144:147], a[248:251], v[224:227]
    ds_write_b128 v140, v[32:35] offset:2048
    v_pk_add_f32 v[64:65], v[160:161], v[192:193]
    v_mfma_f32_16x16x32_bf16 v[228:231], v[144:147], a[236:239], v[228:231]
    v_pk_add_f32 v[66:67], v[162:163], v[194:195]
    v_pk_add_f32 v[36:37], v[180:181], v[212:213]
    v_mfma_f32_16x16x32_bf16 v[232:235], v[144:147], a[240:243], v[232:235]
    s_add_u32 m0, s53, 8192
    s_add_u32 s52, s51, 8192
    buffer_load_dwordx4 v103, s[24:27], s52 offen offset:0 lds
    v_mfma_f32_16x16x32_bf16 v[236:239], v[144:147], a[228:231], v[236:239]
    v_pk_add_f32 v[38:39], v[182:183], v[214:215]
    ds_write_b128 v140, v[36:39] offset:3072
    v_mfma_f32_16x16x32_bf16 v[240:243], v[144:147], a[232:235], v[240:243]
    v_pk_add_f32 v[68:69], v[164:165], v[196:197]
    v_pk_add_f32 v[70:71], v[166:167], v[198:199]
    v_mfma_f32_16x16x32_bf16 v[244:247], v[144:147], a[204:207], v[244:247]
    buffer_load_dwordx4 v103, s[24:27], s52 offen offset:1024 lds
    v_mfma_f32_16x16x32_bf16 v[248:251], v[144:147], a[168:171], v[248:251]
    buffer_load_dwordx4 v103, s[24:27], s52 offen offset:2048 lds
    v_mfma_f32_16x16x32_bf16 v[252:255], v[144:147], a[172:175], v[252:255]
    v_mov_b32 v52, v148
    v_mov_b32 v53, v149
    v_mov_b32 v54, v150
    v_mov_b32 v55, v151
    s_nop 0
    v_add_f32_dpp v52, v216, v148 row_shr:1 row_mask:0xf bank_mask:0xf
    v_add_f32_dpp v53, v217, v149 row_shr:1 row_mask:0xf bank_mask:0xf
    v_add_f32_dpp v54, v218, v150 row_shr:1 row_mask:0xf bank_mask:0xf
    v_add_f32_dpp v55, v219, v151 row_shr:1 row_mask:0xf bank_mask:0xf
    s_waitcnt lgkmcnt(0)
    s_barrier
    ds_read_b128 v[72:75], v141 offset:0
    ds_read_b128 v[76:79], v141 offset:1024
    ds_read_b128 v[80:83], v141 offset:2048
    ds_read_b128 v[84:87], v141 offset:3072
    ds_read_b128 v[88:91], v141 offset:4096
    s_nop 3
    v_pk_add_f32 v[240:241], v[240:241], v[168:169] neg_lo:[0,1] neg_hi:[0,1]
    v_pk_add_f32 v[242:243], v[242:243], v[170:171] neg_lo:[0,1] neg_hi:[0,1]
    v_pk_add_f32 v[240:241], v[240:241], v[204:205] neg_lo:[0,1] neg_hi:[0,1]
    v_pk_add_f32 v[242:243], v[242:243], v[206:207] neg_lo:[0,1] neg_hi:[0,1]
    ds_write_b128 v140, v[240:243] offset:4096
    s_waitcnt lgkmcnt(5)
    v_pk_add_f32 v[72:73], v[72:73], v[52:53]
    v_pk_add_f32 v[74:75], v[74:75], v[54:55]
    v_cvt_pk_bf16_f32 v104, v72, v73
    v_cvt_pk_bf16_f32 v105, v74, v75
    v_pk_add_f32 v[244:245], v[244:245], v[172:173] neg_lo:[0,1] neg_hi:[0,1]
    v_pk_add_f32 v[246:247], v[246:247], v[174:175] neg_lo:[0,1] neg_hi:[0,1]
    v_pk_add_f32 v[244:245], v[244:245], v[208:209] neg_lo:[0,1] neg_hi:[0,1]
    v_pk_add_f32 v[246:247], v[246:247], v[210:211] neg_lo:[0,1] neg_hi:[0,1]
    ds_write_b128 v140, v[244:247] offset:5120
    s_waitcnt lgkmcnt(5)
    v_pk_add_f32 v[76:77], v[76:77], v[56:57]
    v_pk_add_f32 v[78:79], v[78:79], v[58:59]
    v_cvt_pk_bf16_f32 v106, v76, v77
    v_cvt_pk_bf16_f32 v107, v78, v79
    s_mov_b32 s51, 0
    s_nop 0
    v_permlane16_swap_b32 v104, v106
    v_permlane16_swap_b32 v105, v107
    buffer_store_dwordx4 v[104:107], v100, s[32:35], s51 offen sc1
    v_pk_add_f32 v[248:249], v[248:249], v[176:177] neg_lo:[0,1] neg_hi:[0,1]
    v_pk_add_f32 v[250:251], v[250:251], v[178:179] neg_lo:[0,1] neg_hi:[0,1]
    v_pk_add_f32 v[248:249], v[248:249], v[212:213] neg_lo:[0,1] neg_hi:[0,1]
    v_pk_add_f32 v[250:251], v[250:251], v[214:215] neg_lo:[0,1] neg_hi:[0,1]
    ds_write_b128 v140, v[248:251] offset:6144
    s_waitcnt lgkmcnt(5)
    v_pk_add_f32 v[80:81], v[80:81], v[60:61]
    v_pk_add_f32 v[82:83], v[82:83], v[62:63]
    v_cvt_pk_bf16_f32 v108, v80, v81
    v_cvt_pk_bf16_f32 v109, v82, v83
    v_pk_add_f32 v[252:253], v[252:253], v[180:181] neg_lo:[0,1] neg_hi:[0,1]
    v_pk_add_f32 v[254:255], v[254:255], v[182:183] neg_lo:[0,1] neg_hi:[0,1]
    v_pk_add_f32 v[252:253], v[252:253], v[216:217] neg_lo:[0,1] neg_hi:[0,1]
    v_pk_add_f32 v[254:255], v[254:255], v[218:219] neg_lo:[0,1] neg_hi:[0,1]
    ds_write_b128 v140, v[252:255] offset:7168
    s_waitcnt lgkmcnt(5)
    v_pk_add_f32 v[84:85], v[84:85], v[64:65]
    v_pk_add_f32 v[86:87], v[86:87], v[66:67]
    v_cvt_pk_bf16_f32 v110, v84, v85
    v_cvt_pk_bf16_f32 v111, v86, v87
    s_mov_b32 s51, 36864
    s_nop 0
    v_permlane16_swap_b32 v108, v110
    v_permlane16_swap_b32 v109, v111
    buffer_store_dwordx4 v[108:111], v100, s[32:35], s51 offen sc1
    s_waitcnt lgkmcnt(4)
    v_pk_add_f32 v[88:89], v[88:89], v[68:69]
    v_pk_add_f32 v[90:91], v[90:91], v[70:71]
    v_cvt_pk_bf16_f32 v112, v88, v89
    v_cvt_pk_bf16_f32 v113, v90, v91
    v_mov_b32 v114, 0
    v_mov_b32 v115, 0
    s_mov_b32 s51, 73728
    s_nop 0
    v_permlane16_swap_b32 v112, v114
    v_permlane16_swap_b32 v113, v115
    buffer_store_dwordx4 v[112:115], v101, s[32:35], s51 offen sc1
    v_pk_add_f32 v[220:221], v[220:221], v[148:149] neg_lo:[0,1] neg_hi:[0,1]
    v_pk_add_f32 v[222:223], v[222:223], v[150:151] neg_lo:[0,1] neg_hi:[0,1]
    v_pk_add_f32 v[220:221], v[220:221], v[184:185] neg_lo:[0,1] neg_hi:[0,1]
    v_pk_add_f32 v[222:223], v[222:223], v[186:187] neg_lo:[0,1] neg_hi:[0,1]
    v_pk_add_f32 v[224:225], v[224:225], v[152:153] neg_lo:[0,1] neg_hi:[0,1]
    v_pk_add_f32 v[226:227], v[226:227], v[154:155] neg_lo:[0,1] neg_hi:[0,1]
    v_pk_add_f32 v[224:225], v[224:225], v[188:189] neg_lo:[0,1] neg_hi:[0,1]
    v_pk_add_f32 v[226:227], v[226:227], v[190:191] neg_lo:[0,1] neg_hi:[0,1]
    v_pk_add_f32 v[228:229], v[228:229], v[156:157] neg_lo:[0,1] neg_hi:[0,1]
    v_pk_add_f32 v[230:231], v[230:231], v[158:159] neg_lo:[0,1] neg_hi:[0,1]
    v_pk_add_f32 v[228:229], v[228:229], v[192:193] neg_lo:[0,1] neg_hi:[0,1]
    v_pk_add_f32 v[230:231], v[230:231], v[194:195] neg_lo:[0,1] neg_hi:[0,1]
    v_pk_add_f32 v[232:233], v[232:233], v[160:161] neg_lo:[0,1] neg_hi:[0,1]
    v_pk_add_f32 v[234:235], v[234:235], v[162:163] neg_lo:[0,1] neg_hi:[0,1]
    v_pk_add_f32 v[232:233], v[232:233], v[196:197] neg_lo:[0,1] neg_hi:[0,1]
    v_pk_add_f32 v[234:235], v[234:235], v[198:199] neg_lo:[0,1] neg_hi:[0,1]
    v_pk_add_f32 v[236:237], v[236:237], v[164:165] neg_lo:[0,1] neg_hi:[0,1]
    v_pk_add_f32 v[238:239], v[238:239], v[166:167] neg_lo:[0,1] neg_hi:[0,1]
    v_pk_add_f32 v[236:237], v[236:237], v[200:201] neg_lo:[0,1] neg_hi:[0,1]
    v_pk_add_f32 v[238:239], v[238:239], v[202:203] neg_lo:[0,1] neg_hi:[0,1]
    s_waitcnt vmcnt(3)
    s_waitcnt lgkmcnt(0)
    s_barrier
    ds_read_b128 v[72:75], v141 offset:5120
    ds_read_b128 v[76:79], v141 offset:6144
    ds_read_b128 v[80:83], v141 offset:7168
    ds_read_b128 v[84:87], v141 offset:8192
    ds_read_b128 v[88:91], v141 offset:9216
    s_waitcnt lgkmcnt(4)
    v_pk_add_f32 v[72:73], v[72:73], v[220:221]
    v_pk_add_f32 v[74:75], v[74:75], v[222:223]
    v_cvt_pk_bf16_f32 v116, v72, v73
    v_cvt_pk_bf16_f32 v117, v74, v75
    s_waitcnt lgkmcnt(3)
    v_pk_add_f32 v[76:77], v[76:77], v[224:225]
    v_pk_add_f32 v[78:79], v[78:79], v[226:227]
    v_cvt_pk_bf16_f32 v118, v76, v77
    v_cvt_pk_bf16_f32 v119, v78, v79
    s_mov_b32 s51, 1024
    s_nop 0
    v_permlane16_swap_b32 v116, v118
    v_permlane16_swap_b32 v117, v119
    buffer_store_dwordx4 v[116:119], v100, s[32:35], s51 offen sc1
    s_waitcnt lgkmcnt(2)
    v_pk_add_f32 v[80:81], v[80:81], v[228:229]
    v_pk_add_f32 v[82:83], v[82:83], v[230:231]
    v_cvt_pk_bf16_f32 v120, v80, v81
    v_cvt_pk_bf16_f32 v121, v82, v83
    s_waitcnt lgkmcnt(1)
    v_pk_add_f32 v[84:85], v[84:85], v[232:233]
    v_pk_add_f32 v[86:87], v[86:87], v[234:235]
    v_cvt_pk_bf16_f32 v122, v84, v85
    v_cvt_pk_bf16_f32 v123, v86, v87
    s_mov_b32 s51, 37888
    s_nop 0
    v_permlane16_swap_b32 v120, v122
    v_permlane16_swap_b32 v121, v123
    buffer_store_dwordx4 v[120:123], v100, s[32:35], s51 offen sc1
    s_waitcnt lgkmcnt(0)
    v_pk_add_f32 v[88:89], v[88:89], v[236:237]
    v_pk_add_f32 v[90:91], v[90:91], v[238:239]
    v_cvt_pk_bf16_f32 v124, v88, v89
    v_cvt_pk_bf16_f32 v125, v90, v91
    v_mov_b32 v126, 0
    v_mov_b32 v127, 0
    s_mov_b32 s51, 74752
    s_nop 0
    v_permlane16_swap_b32 v124, v126
    v_permlane16_swap_b32 v125, v127
    buffer_store_dwordx4 v[124:127], v101, s[32:35], s51 offen sc1
    s_branch L_red2
L_red1:
    v_mfma_f32_16x16x32_bf16 v[220:223], v[48:51], a[236:239], v[220:223]
    s_add_u32 m0, s53, 4096
    s_add_u32 s52, s51, 4096
    buffer_load_dwordx4 v103, s[24:27], s52 offen offset:0 lds
    v_mfma_f32_16x16x32_bf16 v[224:227], v[48:51], a[240:243], v[224:227]
    v_pk_add_f32 v[28:29], v[152:153], v[184:185]
    v_pk_add_f32 v[30:31], v[154:155], v[186:187]
    v_mfma_f32_16x16x32_bf16 v[228:231], v[48:51], a[228:231], v[228:231]
    ds_write_b128 v140, v[28:31] offset:1024
    v_pk_add_f32 v[52:53], v[168:169], v[200:201]
    v_mfma_f32_16x16x32_bf16 v[232:235], v[48:51], a[232:235], v[232:235]
    buffer_load_dwordx4 v103, s[24:27], s52 offen offset:1024 lds
    v_mfma_f32_16x16x32_bf16 v[236:239], v[48:51], a[204:207], v[236:239]
    v_pk_add_f32 v[54:55], v[170:171], v[202:203]
    v_pk_add_f32 v[32:33], v[156:157], v[188:189]
    v_mfma_f32_16x16x32_bf16 v[240:243], v[48:51], a[168:171], v[240:243]
    v_pk_add_f32 v[34:35], v[158:159], v[190:191]
    ds_write_b128 v140, v[32:35] offset:2048
    v_mfma_f32_16x16x32_bf16 v[244:247], v[48:51], a[172:175], v[244:247]
    buffer_load_dwordx4 v103, s[24:27], s52 offen offset:2048 lds
    v_mfma_f32_16x16x32_bf16 v[248:251], v[48:51], a[184:187], v[248:251]
    v_pk_add_f32 v[56:57], v[172:173], v[204:205]
    v_pk_add_f32 v[58:59], v[174:175], v[206:207]
    v_mfma_f32_16x16x32_bf16 v[252:255], v[48:51], a[188:191], v[252:255]
    v_pk_add_f32 v[36:37], v[160:161], v[192:193]
    v_pk_add_f32 v[38:39], v[162:163], v[194:195]
    v_mfma_f32_16x16x32_bf16 v[220:223], v[144:147], a[244:247], v[220:223]
    buffer_load_dwordx4 v103, s[24:27], s52 offen offset:3072 lds
    v_mfma_f32_16x16x32_bf16 v[224:227], v[144:147], a[248:251], v[224:227]
    ds_write_b128 v140, v[36:39] offset:3072
    v_pk_add_f32 v[60:61], v[176:177], v[208:209]
    v_mfma_f32_16x16x32_bf16 v[228:231], v[144:147], a[236:239], v[228:231]
    v_pk_add_f32 v[62:63], v[178:179], v[210:211]
    v_pk_add_f32 v[40:41], v[164:165], v[196:197]
    v_mfma_f32_16x16x32_bf16 v[232:235], v[144:147], a[240:243], v[232:235]
    s_add_u32 m0, s53, 8192
    s_add_u32 s52, s51, 8192
    buffer_load_dwordx4 v103, s[24:27], s52 offen offset:0 lds
    v_mfma_f32_16x16x32_bf16 v[236:239], v[144:147], a[228:231], v[236:239]
    v_pk_add_f32 v[42:43], v[166:167], v[198:199]
    ds_write_b128 v140, v[40:43] offset:4096
    v_mfma_f32_16x16x32_bf16 v[240:243], v[144:147], a[232:235], v[240:243]
    v_pk_add_f32 v[64:65], v[180:181], v[212:213]
    v_pk_add_f32 v[66:67], v[182:183], v[214:215]
    v_mfma_f32_16x16x32_bf16 v[244:247], v[144:147], a[204:207], v[244:247]
    buffer_load_dwordx4 v103, s[24:27], s52 offen offset:1024 lds
    v_mfma_f32_16x16x32_bf16 v[248:251], v[144:147], a[168:171], v[248:251]
    buffer_load_dwordx4 v103, s[24:27], s52 offen offset:2048 lds
    v_mfma_f32_16x16x32_bf16 v[252:255], v[144:147], a[172:175], v[252:255]
    v_mov_b32 v24, v148
    v_mov_b32 v25, v149
    v_mov_b32 v26, v150
    v_mov_b32 v27, v151
    s_nop 0
    v_add_f32_dpp v24, v216, v148 row_shr:1 row_mask:0xf bank_mask:0xf
    v_add_f32_dpp v25, v217, v149 row_shr:1 row_mask:0xf bank_mask:0xf
    v_add_f32_dpp v26, v218, v150 row_shr:1 row_mask:0xf bank_mask:0xf
    v_add_f32_dpp v27, v219, v151 row_shr:1 row_mask:0xf bank_mask:0xf
    ds_write_b128 v140, v[24:27] offset:0
    s_waitcnt lgkmcnt(0)
    s_barrier
    ds_read_b128 v[72:75], v141 offset:0
    ds_read_b128 v[76:79], v141 offset:1024
    ds_read_b128 v[80:83], v141 offset:2048
    ds_read_b128 v[84:87], v141 offset:3072
    v_pk_add_f32 v[220:221], v[220:221], v[148:149] neg_lo:[0,1] neg_hi:[0,1]
    v_pk_add_f32 v[222:223], v[222:223], v[150:151] neg_lo:[0,1] neg_hi:[0,1]
    v_pk_add_f32 v[220:221], v[220:221], v[184:185] neg_lo:[0,1] neg_hi:[0,1]
    v_pk_add_f32 v[222:223], v[222:223], v[186:187] neg_lo:[0,1] neg_hi:[0,1]
    ds_write_b128 v140, v[220:223] offset:5120
    s_waitcnt lgkmcnt(4)
    v_pk_add_f32 v[72:73], v[72:73], v[52:53]
    v_pk_add_f32 v[74:75], v[74:75], v[54:55]
    v_cvt_pk_bf16_f32 v104, v72, v73
    v_cvt_pk_bf16_f32 v105, v74, v75
    v_pk_add_f32 v[224:225], v[224:225], v[152:153] neg_lo:[0,1] neg_hi:[0,1]
    v_pk_add_f32 v[226:227], v[226:227], v[154:155] neg_lo:[0,1] neg_hi:[0,1]
    v_pk_add_f32 v[224:225], v[224:225], v[188:189] neg_lo:[0,1] neg_hi:[0,1]
    v_pk_add_f32 v[226:227], v[226:227], v[190:191] neg_lo:[0,1] neg_hi:[0,1]
    ds_write_b128 v140, v[224:227] offset:6144
    s_waitcnt lgkmcnt(4)
    v_pk_add_f32 v[76:77], v[76:77], v[56:57]
    v_pk_add_f32 v[78:79], v[78:79], v[58:59]
    v_cvt_pk_bf16_f32 v106, v76, v77
    v_cvt_pk_bf16_f32 v107, v78, v79
    s_mov_b32 s51, 92160
    s_nop 0
    v_permlane16_swap_b32 v104, v106
    v_permlane16_swap_b32 v105, v107
    buffer_store_dwordx4 v[104:107], v100, s[32:35], s51 offen sc1
    v_pk_add_f32 v[228:229], v[228:229], v[156:157] neg_lo:[0,1] neg_hi:[0,1]
    v_pk_add_f32 v[230:231], v[230:231], v[158:159] neg_lo:[0,1] neg_hi:[0,1]
    v_pk_add_f32 v[228:229], v[228:229], v[192:193] neg_lo:[0,1] neg_hi:[0,1]
    v_pk_add_f32 v[230:231], v[230:231], v[194:195] neg_lo:[0,1] neg_hi:[0,1]
    ds_write_b128 v140, v[228:231] offset:7168
    s_waitcnt lgkmcnt(4)
    v_pk_add_f32 v[80:81], v[80:81], v[60:61]
    v_pk_add_f32 v[82:83], v[82:83], v[62:63]
    v_cvt_pk_bf16_f32 v108, v80, v81
    v_cvt_pk_bf16_f32 v109, v82, v83
    v_pk_add_f32 v[232:233], v[232:233], v[160:161] neg_lo:[0,1] neg_hi:[0,1]
    v_pk_add_f32 v[234:235], v[234:235], v[162:163] neg_lo:[0,1] neg_hi:[0,1]
    v_pk_add_f32 v[232:233], v[232:233], v[196:197] neg_lo:[0,1] neg_hi:[0,1]
    v_pk_add_f32 v[234:235], v[234:235], v[198:199] neg_lo:[0,1] neg_hi:[0,1]
    ds_write_b128 v140, v[232:235] offset:8192
    s_waitcnt lgkmcnt(4)
    v_pk_add_f32 v[84:85], v[84:85], v[64:65]
    v_pk_add_f32 v[86:87], v[86:87], v[66:67]
    v_cvt_pk_bf16_f32 v110, v84, v85
    v_cvt_pk_bf16_f32 v111, v86, v87
    s_mov_b32 s51, 129024
    s_nop 0
    v_permlane16_swap_b32 v108, v110
    v_permlane16_swap_b32 v109, v111
    buffer_store_dwordx4 v[108:111], v100, s[32:35], s51 offen sc1
    v_pk_add_f32 v[236:237], v[236:237], v[164:165] neg_lo:[0,1] neg_hi:[0,1]
    v_pk_add_f32 v[238:239], v[238:239], v[166:167] neg_lo:[0,1] neg_hi:[0,1]
    v_pk_add_f32 v[236:237], v[236:237], v[200:201] neg_lo:[0,1] neg_hi:[0,1]
    v_pk_add_f32 v[238:239], v[238:239], v[202:203] neg_lo:[0,1] neg_hi:[0,1]
    ds_write_b128 v140, v[236:239] offset:9216
    v_pk_add_f32 v[240:241], v[240:241], v[168:169] neg_lo:[0,1] neg_hi:[0,1]
    v_pk_add_f32 v[242:243], v[242:243], v[170:171] neg_lo:[0,1] neg_hi:[0,1]
    v_pk_add_f32 v[240:241], v[240:241], v[204:205] neg_lo:[0,1] neg_hi:[0,1]
    v_pk_add_f32 v[242:243], v[242:243], v[206:207] neg_lo:[0,1] neg_hi:[0,1]
    v_pk_add_f32 v[244:245], v[244:245], v[172:173] neg_lo:[0,1] neg_hi:[0,1]
    v_pk_add_f32 v[246:247], v[246:247], v[174:175] neg_lo:[0,1] neg_hi:[0,1]
    v_pk_add_f32 v[244:245], v[244:245], v[208:209] neg_lo:[0,1] neg_hi:[0,1]
    v_pk_add_f32 v[246:247], v[246:247], v[210:211] neg_lo:[0,1] neg_hi:[0,1]
    v_pk_add_f32 v[248:249], v[248:249], v[176:177] neg_lo:[0,1] neg_hi:[0,1]
    v_pk_add_f32 v[250:251], v[250:251], v[178:179] neg_lo:[0,1] neg_hi:[0,1]
    v_pk_add_f32 v[248:249], v[248:249], v[212:213] neg_lo:[0,1] neg_hi:[0,1]
    v_pk_add_f32 v[250:251], v[250:251], v[214:215] neg_lo:[0,1] neg_hi:[0,1]
    v_pk_add_f32 v[252:253], v[252:253], v[180:181] neg_lo:[0,1] neg_hi:[0,1]
    v_pk_add_f32 v[254:255], v[254:255], v[182:183] neg_lo:[0,1] neg_hi:[0,1]
    v_pk_add_f32 v[252:253], v[252:253], v[216:217] neg_lo:[0,1] neg_hi:[0,1]
    v_pk_add_f32 v[254:255], v[254:255], v[218:219] neg_lo:[0,1] neg_hi:[0,1]
    s_waitcnt vmcnt(2)
    s_waitcnt lgkmcnt(0)
    s_barrier
    ds_read_b128 v[72:75], v141 offset:4096
    ds_read_b128 v[76:79], v141 offset:5120
    ds_read_b128 v[80:83], v141 offset:6144
    ds_read_b128 v[84:87], v141 offset:7168
    s_waitcnt lgkmcnt(3)
    v_pk_add_f32 v[72:73], v[72:73], v[240:241]
    v_pk_add_f32 v[74:75], v[74:75], v[242:243]
    v_cvt_pk_bf16_f32 v116, v72, v73
    v_cvt_pk_bf16_f32 v117, v74, v75
    s_waitcnt lgkmcnt(2)
    v_pk_add_f32 v[76:77], v[76:77], v[244:245]
    v_pk_add_f32 v[78:79], v[78:79], v[246:247]
    v_cvt_pk_bf16_f32 v118, v76, v77
    v_cvt_pk_bf16_f32 v119, v78, v79
    s_mov_b32 s51, 93184
    s_nop 0
    v_permlane16_swap_b32 v116, v118
    v_permlane16_swap_b32 v117, v119
    buffer_store_dwordx4 v[116:119], v100, s[32:35], s51 offen sc1
    s_waitcnt lgkmcnt(1)
    v_pk_add_f32 v[80:81], v[80:81], v[248:249]
    v_pk_add_f32 v[82:83], v[82:83], v[250:251]
    v_cvt_pk_bf16_f32 v120, v80, v81
    v_cvt_pk_bf16_f32 v121, v82, v83
    s_waitcnt lgkmcnt(0)
    v_pk_add_f32 v[84:85], v[84:85], v[252:253]
    v_pk_add_f32 v[86:87], v[86:87], v[254:255]
    v_cvt_pk_bf16_f32 v122, v84, v85
    v_cvt_pk_bf16_f32 v123, v86, v87
    s_mov_b32 s51, 130048
    s_nop 0
    v_permlane16_swap_b32 v120, v122
    v_permlane16_swap_b32 v121, v123
    buffer_store_dwordx4 v[120:123], v100, s[32:35], s51 offen sc1
L_red2:
    buffer_store_dword v8, v142, s[32:35], 0 offen sc1
    ds_read_b64_tr_b16 a[0:1], v132 offset:0
    ds_read_b64_tr_b16 a[2:3], v132 offset:1152
    ds_read_b64_tr_b16 a[4:5], v132 offset:9216
    ds_read_b64_tr_b16 a[6:7], v132 offset:10368
    ds_read_b64_tr_b16 a[8:9], v132 offset:18432
    ds_read_b64_tr_b16 a[10:11], v132 offset:19584
    ds_read_b64_tr_b16 a[12:13], v132 offset:27648
    ds_read_b64_tr_b16 a[14:15], v132 offset:28800
    ds_read_b64_tr_b16 a[16:17], v133 offset:0
    ds_read_b64_tr_b16 a[18:19], v132 offset:32
    ds_read_b64_tr_b16 a[20:21], v132 offset:1184
    ds_read_b64_tr_b16 a[22:23], v132 offset:9248
    ds_read_b64_tr_b16 a[24:25], v132 offset:10400
    ds_read_b64_tr_b16 a[26:27], v132 offset:18464
    ds_read_b64_tr_b16 a[28:29], v132 offset:19616
    ds_read_b64_tr_b16 a[30:31], v132 offset:27680
    ds_read_b64_tr_b16 a[32:33], v132 offset:28832
    ds_read_b64_tr_b16 a[34:35], v133 offset:32
    ds_read_b64_tr_b16 a[36:37], v132 offset:64
    ds_read_b64_tr_b16 a[38:39], v132 offset:1216
    ds_read_b64_tr_b16 a[40:41], v132 offset:9280
    ds_read_b64_tr_b16 a[42:43], v132 offset:10432
    ds_read_b64_tr_b16 a[44:45], v132 offset:18496
    ds_read_b64_tr_b16 a[46:47], v132 offset:19648
    ds_read_b64_tr_b16 a[48:49], v132 offset:27712
    ds_read_b64_tr_b16 a[50:51], v132 offset:28864
    ds_read_b64_tr_b16 a[52:53], v133 offset:64
    ds_read_b64_tr_b16 a[54:55], v132 offset:96
    ds_read_b64_tr_b16 a[56:57], v132 offset:1248
    ds_read_b64_tr_b16 a[58:59], v132 offset:9312
    ds_read_b64_tr_b16 a[60:61], v132 offset:10464
    ds_read_b64_tr_b16 a[62:63], v132 offset:18528
    ds_read_b64_tr_b16 a[64:65], v132 offset:19680
    ds_read_b64_tr_b16 a[66:67], v132 offset:27744
    ds_read_b64_tr_b16 a[68:69], v132 offset:28896
    ds_read_b64_tr_b16 a[70:71], v133 offset:96
    ds_read_b64_tr_b16 a[72:73], v132 offset:128
    ds_read_b64_tr_b16 a[74:75], v132 offset:1280
    ds_read_b64_tr_b16 a[76:77], v132 offset:9344
    ds_read_b64_tr_b16 a[78:79], v132 offset:10496
    ds_read_b64_tr_b16 a[80:81], v132 offset:18560
    ds_read_b64_tr_b16 a[82:83], v132 offset:19712
    ds_read_b64_tr_b16 a[84:85], v132 offset:27776
    ds_read_b64_tr_b16 a[86:87], v132 offset:28928
    ds_read_b64_tr_b16 a[88:89], v133 offset:128
    s_waitcnt vmcnt(0)
    s_mov_b32 s63, 0
    buffer_load_dwordx4 v[80:83], v128, s[32:35], 0 offen offset:0 sc1
    buffer_load_dwordx4 v[84:87], v129, s[32:35], 0 offen offset:0 sc1
    buffer_load_dwordx4 v[88:91], v128, s[32:35], 0 offen offset:2048 sc1
    buffer_load_dwordx4 v[92:95], v129, s[32:35], 0 offen offset:2048 sc1
    buffer_load_dword v96, v130, s[32:35], 0 offen sc1
    buffer_load_dword v97, v131, s[32:35], 0 offen sc1
    s_branch L_hpollw
L_hpoll:
    buffer_load_dwordx4 v[80:83], v128, s[32:35], 0 offen offset:0 sc1
    buffer_load_dwordx4 v[84:87], v129, s[32:35], 0 offen offset:0 sc1
    buffer_load_dwordx4 v[88:91], v128, s[32:35], 0 offen offset:2048 sc1
    buffer_load_dwordx4 v[92:95], v129, s[32:35], 0 offen offset:2048 sc1
    buffer_load_dword v96, v130, s[32:35], 0 offen sc1
    buffer_load_dword v97, v131, s[32:35], 0 offen sc1
L_hpollw:
    s_add_u32 s63, s63, 1
    s_waitcnt vmcnt(0)
    v_max3_u32 v40, v80, v81, v82
    v_max3_u32 v41, v83, v84, v85
    v_max3_u32 v42, v86, v87, v88
    v_max3_u32 v43, v89, v90, v91
    v_max3_u32 v44, v92, v93, v94
    v_max3_u32 v45, v95, v96, v97
    v_max3_u32 v40, v40, v41, v42
    v_max3_u32 v43, v43, v44, v45
    v_max_u32 v40, v40, v43
    v_cmp_eq_u32 vcc, -1, v40
    s_cmp_lt_u32 s63, 262144
    s_cselect_b64 s[96:97], -1, 0
    s_nop 2
    s_and_b64 vcc, vcc, s[96:97]
    s_cbranch_vccnz L_hpoll
    v_lshlrev_b32 v24, 16, v80
    v_and_b32 v25, s47, v80
    v_lshlrev_b32 v32, 16, v84
    v_and_b32 v33, s47, v84
    v_lshlrev_b32 v26, 16, v81
    v_and_b32 v27, s47, v81
    v_lshlrev_b32 v34, 16, v85
    v_and_b32 v35, s47, v85
    v_lshlrev_b32 v28, 16, v82
    v_and_b32 v29, s47, v82
    v_lshlrev_b32 v36, 16, v86
    v_and_b32 v37, s47, v86
    v_lshlrev_b32 v30, 16, v83
    v_and_b32 v31, s47, v83
    v_lshlrev_b32 v38, 16, v87
    v_and_b32 v39, s47, v87
    v_pk_mul_f32 v[24:25], v[24:25], v[10:11]
    v_pk_mul_f32 v[26:27], v[26:27], v[10:11]
    v_pk_mul_f32 v[28:29], v[28:29], v[10:11]
    v_pk_mul_f32 v[30:31], v[30:31], v[10:11]
    v_pk_mul_f32 v[32:33], v[32:33], v[16:17]
    v_pk_mul_f32 v[34:35], v[34:35], v[16:17]
    v_pk_mul_f32 v[36:37], v[36:37], v[16:17]
    v_pk_mul_f32 v[38:39], v[38:39], v[16:17]
    v_min_f32 v24, s8, v24
    v_min_f32 v25, s8, v25
    v_min_f32 v26, s8, v26
    v_min_f32 v27, s8, v27
    v_min_f32 v28, s8, v28
    v_min_f32 v29, s8, v29
    v_min_f32 v30, s8, v30
    v_min_f32 v31, s8, v31
    v_exp_f32 v32, v32
    v_exp_f32 v33, v33
    v_exp_f32 v34, v34
    v_exp_f32 v35, v35
    v_exp_f32 v36, v36
    v_exp_f32 v37, v37
    v_exp_f32 v38, v38
    v_exp_f32 v39, v39
    v_exp_f32 v24, v24
    v_exp_f32 v25, v25
    v_exp_f32 v26, v26
    v_exp_f32 v27, v27
    v_exp_f32 v28, v28
    v_exp_f32 v29, v29
    v_exp_f32 v30, v30
    v_exp_f32 v31, v31
    s_nop 0
    v_pk_add_f32 v[40:41], v[24:25], v[20:21]
    v_pk_add_f32 v[42:43], v[26:27], v[20:21]
    v_pk_add_f32 v[44:45], v[28:29], v[20:21]
    v_pk_add_f32 v[46:47], v[30:31], v[20:21]
    v_pk_fma_f32 v[40:41], v[40:41], v[32:33], v[40:41]
    v_pk_fma_f32 v[42:43], v[42:43], v[34:35], v[42:43]
    v_pk_fma_f32 v[44:45], v[44:45], v[36:37], v[44:45]
    v_pk_fma_f32 v[46:47], v[46:47], v[38:39], v[46:47]
    v_rcp_f32 v40, v40
    v_rcp_f32 v41, v41
    v_rcp_f32 v42, v42
    v_rcp_f32 v43, v43
    v_rcp_f32 v44, v44
    v_rcp_f32 v45, v45
    v_rcp_f32 v46, v46
    v_rcp_f32 v47, v47
    v_pk_add_f32 v[24:25], v[20:21], v[24:25] neg_lo:[0,1] neg_hi:[0,1]
    v_pk_add_f32 v[26:27], v[20:21], v[26:27] neg_lo:[0,1] neg_hi:[0,1]
    v_pk_add_f32 v[28:29], v[20:21], v[28:29] neg_lo:[0,1] neg_hi:[0,1]
    v_pk_add_f32 v[30:31], v[20:21], v[30:31] neg_lo:[0,1] neg_hi:[0,1]
    s_nop 0
    v_pk_mul_f32 v[24:25], v[24:25], v[40:41]
    v_pk_mul_f32 v[26:27], v[26:27], v[42:43]
    v_pk_mul_f32 v[28:29], v[28:29], v[44:45]
    v_pk_mul_f32 v[30:31], v[30:31], v[46:47]
    v_cvt_pk_bf16_f32 v48, v24, v25
    v_cvt_pk_bf16_f32 v49, v26, v27
    v_cvt_pk_bf16_f32 v50, v28, v29
    v_cvt_pk_bf16_f32 v51, v30, v31
    ds_write_b128 v134, v[48:51] offset:0
    v_lshlrev_b32 v24, 16, v88
    v_and_b32 v25, s47, v88
    v_lshlrev_b32 v32, 16, v92
    v_and_b32 v33, s47, v92
    v_lshlrev_b32 v26, 16, v89
    v_and_b32 v27, s47, v89
    v_lshlrev_b32 v34, 16, v93
    v_and_b32 v35, s47, v93
    v_lshlrev_b32 v28, 16, v90
    v_and_b32 v29, s47, v90
    v_lshlrev_b32 v36, 16, v94
    v_and_b32 v37, s47, v94
    v_lshlrev_b32 v30, 16, v91
    v_and_b32 v31, s47, v91
    v_lshlrev_b32 v38, 16, v95
    v_and_b32 v39, s47, v95
    v_pk_mul_f32 v[24:25], v[24:25], v[10:11]
    v_pk_mul_f32 v[26:27], v[26:27], v[10:11]
    v_pk_mul_f32 v[28:29], v[28:29], v[10:11]
    v_pk_mul_f32 v[30:31], v[30:31], v[10:11]
    v_pk_mul_f32 v[32:33], v[32:33], v[16:17]
    v_pk_mul_f32 v[34:35], v[34:35], v[16:17]
    v_pk_mul_f32 v[36:37], v[36:37], v[16:17]
    v_pk_mul_f32 v[38:39], v[38:39], v[16:17]
    v_min_f32 v24, s8, v24
    v_min_f32 v25, s8, v25
    v_min_f32 v26, s8, v26
    v_min_f32 v27, s8, v27
    v_min_f32 v28, s8, v28
    v_min_f32 v29, s8, v29
    v_min_f32 v30, s8, v30
    v_min_f32 v31, s8, v31
    v_exp_f32 v32, v32
    v_exp_f32 v33, v33
    v_exp_f32 v34, v34
    v_exp_f32 v35, v35
    v_exp_f32 v36, v36
    v_exp_f32 v37, v37
    v_exp_f32 v38, v38
    v_exp_f32 v39, v39
    v_exp_f32 v24, v24
    v_exp_f32 v25, v25
    v_exp_f32 v26, v26
    v_exp_f32 v27, v27
    v_exp_f32 v28, v28
    v_exp_f32 v29, v29
    v_exp_f32 v30, v30
    v_exp_f32 v31, v31
    s_nop 0
    v_pk_add_f32 v[40:41], v[24:25], v[20:21]
    v_pk_add_f32 v[42:43], v[26:27], v[20:21]
    v_pk_add_f32 v[44:45], v[28:29], v[20:21]
    v_pk_add_f32 v[46:47], v[30:31], v[20:21]
    v_pk_fma_f32 v[40:41], v[40:41], v[32:33], v[40:41]
    v_pk_fma_f32 v[42:43], v[42:43], v[34:35], v[42:43]
    v_pk_fma_f32 v[44:45], v[44:45], v[36:37], v[44:45]
    v_pk_fma_f32 v[46:47], v[46:47], v[38:39], v[46:47]
    v_rcp_f32 v40, v40
    v_rcp_f32 v41, v41
    v_rcp_f32 v42, v42
    v_rcp_f32 v43, v43
    v_rcp_f32 v44, v44
    v_rcp_f32 v45, v45
    v_rcp_f32 v46, v46
    v_rcp_f32 v47, v47
    v_pk_add_f32 v[24:25], v[20:21], v[24:25] neg_lo:[0,1] neg_hi:[0,1]
    v_pk_add_f32 v[26:27], v[20:21], v[26:27] neg_lo:[0,1] neg_hi:[0,1]
    v_pk_add_f32 v[28:29], v[20:21], v[28:29] neg_lo:[0,1] neg_hi:[0,1]
    v_pk_add_f32 v[30:31], v[20:21], v[30:31] neg_lo:[0,1] neg_hi:[0,1]
    s_nop 0
    v_pk_mul_f32 v[24:25], v[24:25], v[40:41]
    v_pk_mul_f32 v[26:27], v[26:27], v[42:43]
    v_pk_mul_f32 v[28:29], v[28:29], v[44:45]
    v_pk_mul_f32 v[30:31], v[30:31], v[46:47]
    v_cvt_pk_bf16_f32 v52, v24, v25
    v_cvt_pk_bf16_f32 v53, v26, v27
    v_cvt_pk_bf16_f32 v54, v28, v29
    v_cvt_pk_bf16_f32 v55, v30, v31
    ds_write_b128 v134, v[52:55] offset:1024
    v_lshlrev_b32 v24, 16, v96
    v_and_b32 v25, s47, v96
    v_lshlrev_b32 v32, 16, v97
    v_and_b32 v33, s47, v97
    v_pk_mul_f32 v[24:25], v[24:25], v[10:11]
    v_pk_mul_f32 v[32:33], v[32:33], v[16:17]
    v_min_f32 v24, s8, v24
    v_min_f32 v25, s8, v25
    v_exp_f32 v32, v32
    v_exp_f32 v33, v33
    v_exp_f32 v24, v24
    v_exp_f32 v25, v25
    s_nop 0
    v_pk_add_f32 v[40:41], v[24:25], v[20:21]
    v_pk_fma_f32 v[40:41], v[40:41], v[32:33], v[40:41]
    v_rcp_f32 v40, v40
    v_rcp_f32 v41, v41
    v_pk_add_f32 v[24:25], v[20:21], v[24:25] neg_lo:[0,1] neg_hi:[0,1]
    s_nop 0
    v_pk_mul_f32 v[24:25], v[24:25], v[40:41]
    v_cvt_pk_bf16_f32 v56, v24, v25
    ds_write_b32 v135, v56
    s_waitcnt lgkmcnt(0)
    s_barrier
    ds_read_b128 v[60:63], v136 offset:0
    ds_read_b128 v[64:67], v136 offset:1024
    ds_read_b128 v[68:71], v136 offset:2048
    ds_read_b128 v[72:75], v136 offset:3072
    ds_read_b64 v[76:77], v137
    v_mov_b32 v54, 0
    v_mov_b32 v55, 0
    s_waitcnt lgkmcnt(4)
    v_mfma_f32_16x16x32_bf16 v[24:27], a[0:3], v[60:63], 0
    s_waitcnt lgkmcnt(3)
    v_mfma_f32_16x16x32_bf16 v[24:27], a[4:7], v[64:67], v[24:27]
    s_waitcnt lgkmcnt(2)
    v_mfma_f32_16x16x32_bf16 v[24:27], a[8:11], v[68:71], v[24:27]
    s_waitcnt lgkmcnt(1)
    v_mfma_f32_16x16x32_bf16 v[24:27], a[12:15], v[72:75], v[24:27]
    v_mfma_f32_16x16x32_bf16 v[28:31], a[18:21], v[60:63], 0
    v_mfma_f32_16x16x32_bf16 v[28:31], a[22:25], v[64:67], v[28:31]
    v_mfma_f32_16x16x32_bf16 v[28:31], a[26:29], v[68:71], v[28:31]
    v_mfma_f32_16x16x32_bf16 v[28:31], a[30:33], v[72:75], v[28:31]
    v_mfma_f32_16x16x32_bf16 v[32:35], a[36:39], v[60:63], 0
    v_mfma_f32_16x16x32_bf16 v[32:35], a[40:43], v[64:67], v[32:35]
    v_mfma_f32_16x16x32_bf16 v[32:35], a[44:47], v[68:71], v[32:35]
    v_mfma_f32_16x16x32_bf16 v[32:35], a[48:51], v[72:75], v[32:35]
    s_waitcnt lgkmcnt(0)
    v_mfma_f32_16x16x16_bf16 v[24:27], a[16:17], v[76:77], v[24:27]
    v_mfma_f32_16x16x32_bf16 v[36:39], a[54:57], v[60:63], 0
    v_mfma_f32_16x16x32_bf16 v[36:39], a[58:61], v[64:67], v[36:39]
    v_mfma_f32_16x16x32_bf16 v[36:39], a[62:65], v[68:71], v[36:39]
    v_mfma_f32_16x16x32_bf16 v[36:39], a[66:69], v[72:75], v[36:39]
    v_mfma_f32_16x16x16_bf16 v[28:31], a[34:35], v[76:77], v[28:31]
    v_mfma_f32_16x16x32_bf16 v[40:43], a[72:75], v[60:63], 0
    v_mfma_f32_16x16x32_bf16 v[40:43], a[76:79], v[64:67], v[40:43]
    v_mfma_f32_16x16x32_bf16 v[40:43], a[80:83], v[68:71], v[40:43]
    v_mfma_f32_16x16x32_bf16 v[40:43], a[84:87], v[72:75], v[40:43]
    v_mfma_f32_16x16x16_bf16 v[32:35], a[52:53], v[76:77], v[32:35]
    v_mfma_f32_16x16x16_bf16 v[36:39], a[70:71], v[76:77], v[36:39]
    v_cvt_pk_bf16_f32 v44, v24, v25
    v_cvt_pk_bf16_f32 v45, v26, v27
    v_cvt_pk_bf16_f32 v46, v28, v29
    v_cvt_pk_bf16_f32 v47, v30, v31
    v_mfma_f32_16x16x16_bf16 v[40:43], a[88:89], v[76:77], v[40:43]
    s_nop 1
    v_permlane16_swap_b32 v44, v46
    v_permlane16_swap_b32 v45, v47
    buffer_store_dwordx4 v[44:47], v138, s[28:31], 0 offen offset:0
    v_cvt_pk_bf16_f32 v48, v32, v33
    v_cvt_pk_bf16_f32 v49, v34, v35
    v_cvt_pk_bf16_f32 v50, v36, v37
    v_cvt_pk_bf16_f32 v51, v38, v39
    s_nop 1
    v_permlane16_swap_b32 v48, v50
    v_permlane16_swap_b32 v49, v51
    buffer_store_dwordx4 v[48:51], v138, s[28:31], 0 offen offset:64
    v_cvt_pk_bf16_f32 v52, v40, v41
    v_cvt_pk_bf16_f32 v53, v42, v43
    s_nop 1
    v_permlane16_swap_b32 v52, v54
    v_permlane16_swap_b32 v53, v55
    buffer_store_dwordx4 v[52:55], v139, s[28:31], 0 offen offset:128
L_end:
    s_endpgm
L_code_end:
.section .rodata,"a"
.p2align 6
.amdhsa_kernel standalone__autoregressive_conv_wavenet__speech_kernel
  .amdhsa_next_free_vgpr 512
  .amdhsa_next_free_sgpr 102
  .amdhsa_accum_offset 256
  .amdhsa_group_segment_fixed_size 0
  .amdhsa_kernarg_size 48
  .amdhsa_user_sgpr_count 2
  .amdhsa_user_sgpr_kernarg_segment_ptr 1
  .amdhsa_system_sgpr_workgroup_id_x 1
.end_amdhsa_kernel
```
